```python
import torch

def _softmax(x, axis=-1):
    return torch.softmax(x, dim=axis)
def _gelu(x):
    return torch.nn.functional.gelu(x, approximate="tanh")
def _silu(x):
    return torch.nn.functional.silu(x)
def _sigmoid(x):
    return torch.sigmoid(x)
def _layernorm(x, axis=-1, eps=1e-5):
    m = x.mean(dim=axis, keepdim=True)
    v = x.var(dim=axis, keepdim=True, unbiased=False)
    return (x - m) / torch.sqrt(v + eps)
def _scatter_add(tgt, idx, src, axis=0):
    return tgt.clone().index_add_(axis, idx, src)
def _segment_sum(src, seg, n):
    out = torch.zeros((n,) + src.shape[1:], dtype=src.dtype)
    return out.index_add_(0, seg, src)
def _pad(x, pw):
    flat = tuple(v for pair in reversed(pw) for v in pair)
    return torch.nn.functional.pad(x, flat)

kernel_name = 'standalone__linear_kernel_rfa__decode'

def setup_inputs():

    _w = (lambda a: (lambda t: t.to(torch.bfloat16) if t.is_floating_point() else t)(torch.as_tensor(a)))
    B, H, Sq, Sk, D, M = 1, 32, 1, 8192, 128, 16
    return {
        "q": _w((lambda *s: torch.randn(*s, dtype=torch.bfloat16) * 0.4)(B, H, Sq, D)),
        "k": _w((lambda *s: torch.randn(*s, dtype=torch.bfloat16) * 1.6)(B, H, Sk, D)),
        "v": _w((lambda *s: torch.randn(*s, dtype=torch.bfloat16) * 1.6)(B, H, Sk, D)),
        "omega": _w((lambda *s: torch.randn(*s, dtype=torch.bfloat16) * 1.6)(M, D)),
    }

def reference(q, k, v, omega):
    d = q.shape[-1]
    m = omega.shape[0]
    scale = float(d) ** -0.25
    qs = q * scale
    ks = k * scale
    q_proj = torch.einsum("bhsd,md->bhsm", qs, omega)
    k_proj = torch.einsum("bhsd,md->bhsm", ks, omega)
    q_sq = 0.5 * torch.einsum("bhsd,bhsd->bhs", qs, qs)[..., None]
    k_sq = 0.5 * torch.einsum("bhsd,bhsd->bhs", ks, ks)[..., None]
    inv_sqrt_m = float(m) ** -0.5
    phi_q = torch.exp(q_proj - q_sq) * inv_sqrt_m + 1e-6
    phi_k = torch.exp(k_proj - k_sq) * inv_sqrt_m + 1e-6
    kv = torch.einsum("bhsm,bhsd->bhmd", phi_k, v)
    z  = torch.einsum("bhsm->bhm", phi_k)
    num = torch.einsum("bhqm,bhmd->bhqd", phi_q, kv)
    den = torch.einsum("bhqm,bhm->bhq", phi_q, z)[..., None] + 1e-6
    return num / den
```

```asm
; @launch grid=(256,1,1) block=(256,1,1) lds=90000
.amdgcn_target "amdgcn-amd-amdhsa--gfx950"
.text
.globl standalone__linear_kernel_rfa__decode_kernel
.p2align 8
.type standalone__linear_kernel_rfa__decode_kernel,@function
standalone__linear_kernel_rfa__decode_kernel:
    s_load_dwordx4 s[4:7], s[0:1], 0
    s_load_dwordx4 s[8:11], s[0:1], 16
    s_load_dwordx4 s[12:15], s[0:1], 32
    s_load_dwordx2 s[16:17], s[0:1], 48
    s_cmp_ge_u32 s2, 256
    s_cbranch_scc1 L_end
    v_lshrrev_b32 v59, 6, v0
    v_lshlrev_b32 v40, 4, v0
    v_and_b32 v0, 63, v0
    v_readfirstlane_b32 s31, v59
    v_and_b32 v48, 15, v0
    v_lshrrev_b32 v49, 4, v0
    v_lshlrev_b32 v58, 4, v49
    v_lshl_add_u32 v1, v48, 8, v58
    v_lshlrev_b32 v2, 10, v49
    v_lshl_add_u32 v2, v48, 4, v2
    s_lshr_b32 s33, s2, 3
    s_lshl_b32 s58, s33, 21
    s_lshl_b32 s18, s31, 12
    s_add_u32 s58, s58, s18
    s_add_u32 s65, s2, s33
    s_and_b32 s65, s65, 7
    s_lshl_b32 s65, s65, 14
    s_and_b32 s56, s33, 15
    s_lshl_b32 s56, s56, 17
    s_add_u32 s68, s58, s56
    s_add_u32 s68, s68, s65
    s_lshl_b32 s18, s33, 8
    v_lshl_add_u32 v41, v0, 4, s18
    s_lshl_b32 s19, s33, 7
    s_add_u32 s19, s19, 0x100000
    s_mov_b32 s22, 0x4000000
    s_mov_b32 s23, 0x20000
    s_mov_b32 s26, 0x4000000
    s_mov_b32 s27, 0x20000
    s_waitcnt lgkmcnt(0)
    s_mov_b32 s20, s6
    s_mov_b32 s21, s7
    s_mov_b32 s24, s8
    s_mov_b32 s25, s9
    s_load_dword s57, s[16:17], s19
    s_cmp_lg_u32 s31, 0
    s_cbranch_scc1 L_noq
    s_mov_b32 m0, 4096
    s_mov_b64 exec, 0xffff
    global_load_lds_dwordx4 v41, s[4:5]
    s_mov_b64 exec, -1
L_noq:
    s_lshl_b32 m0, s31, 10
    s_nop 0
    global_load_lds_dwordx4 v40, s[10:11]
    buffer_load_dwordx4 v[104:107], v1, s[20:23], s68 offen offset:0 nt
    buffer_load_dwordx4 v[108:111], v1, s[20:23], s68 offen offset:64 nt
    buffer_load_dwordx4 v[112:115], v1, s[20:23], s68 offen offset:128 nt
    buffer_load_dwordx4 v[116:119], v1, s[20:23], s68 offen offset:192 nt
    buffer_load_dwordx4 a[0:3], v2, s[24:27], s68 offen offset:0 nt
    buffer_load_dwordx4 a[4:7], v2, s[24:27], s68 offen offset:256 nt
    buffer_load_dwordx4 a[8:11], v2, s[24:27], s68 offen offset:512 nt
    buffer_load_dwordx4 a[12:15], v2, s[24:27], s68 offen offset:768 nt
    s_add_u32 s56, s56, 131072
    s_and_b32 s56, s56, 2097151
    s_add_u32 s69, s58, s56
    s_add_u32 s65, s65, 0x4000
    s_and_b32 s65, s65, 0x1ffff
    s_add_u32 s69, s69, s65
    buffer_load_dwordx4 v[120:123], v1, s[20:23], s69 offen offset:0 nt
    buffer_load_dwordx4 v[124:127], v1, s[20:23], s69 offen offset:64 nt
    buffer_load_dwordx4 v[128:131], v1, s[20:23], s69 offen offset:128 nt
    buffer_load_dwordx4 v[132:135], v1, s[20:23], s69 offen offset:192 nt
    s_mov_b32 s34, 0x3e9837f0
    s_mov_b32 s35, 0x3e9837f0
    s_mov_b32 s36, 0xffff0000
    s_mov_b32 s37, 0x3fb8aa3b
    s_mov_b32 s38, 0x35860000
    s_mov_b32 s48, 0x100001
    s_mov_b32 s49, 0x10000100
    s_mov_b32 s50, 0x200002
    s_mov_b32 s51, 0x20000200
    s_mov_b32 s52, 0x400004
    s_mov_b32 s53, 0x40000400
    s_mov_b32 s54, 0x800008
    s_mov_b32 s55, 0x80000800
    v_mov_b32 v3, 1.0
    v_mov_b32 v12, 0
    v_mov_b32 v16, 0
    v_mov_b32 v13, 0
    v_mov_b32 v17, 0
    v_mov_b32 v14, 0
    v_mov_b32 v18, 0
    v_mov_b32 v15, 0
    v_mov_b32 v19, 0
    v_mov_b32 v50, 0x0706
    v_mov_b32 v51, 0x0302
    v_cmp_gt_u32 vcc, 8, v48
    s_nop 1
    v_cndmask_b32 v50, v51, v50, vcc
    v_lshlrev_b32 v51, 16, v50
    v_or_b32 v51, 0x0c0c, v51
    v_or_b32 v50, 0x0c0c0000, v50
    v_and_b32 v52, 1, v48
    v_cmp_eq_u32 vcc, 1, v52
    s_nop 1
    v_cndmask_b32 v50, v50, v51, vcc
    v_bfe_u32 v52, v48, 1, 2
    v_mov_b32 v51, 0x0c0c0c0c
    v_cmp_eq_u32 vcc, 0, v52
    s_nop 1
    v_cndmask_b32 v4, v51, v50, vcc
    v_cmp_eq_u32 vcc, 1, v52
    s_nop 1
    v_cndmask_b32 v5, v51, v50, vcc
    v_cmp_eq_u32 vcc, 2, v52
    s_nop 1
    v_cndmask_b32 v6, v51, v50, vcc
    v_cmp_eq_u32 vcc, 3, v52
    s_nop 1
    v_cndmask_b32 v7, v51, v50, vcc
    s_lshl_b32 s18, s31, 10
    s_lshl_b32 s3, s31, 8
    v_lshlrev_b32 v78, 4, v0
    v_lshlrev_b32 v79, 2, v0
    v_add_u32 v76, s18, v78
    v_add_u32 v77, s3, v79
    s_xor_b32 s39, s2, s33
    s_and_b32 s39, s39, 7
    s_lshl_b32 s18, s33, 13
    v_add_u32 v81, s18, v78
    s_lshl_b32 s18, s39, 10
    v_add_u32 v80, s18, v81
    v_add_u32 v82, 4096, v81
    v_bfe_u32 v37, v0, 4, 1
    v_lshlrev_b32 v36, 4, v48
    v_lshl_add_u32 v36, v37, 3, v36
    s_lshl_b32 s18, s33, 8
    v_add_u32 v83, s18, v36
    v_mov_b32 v84, s19
    s_lshl_b32 s18, s33, 13
    v_add_u32 v81, s18, v78
    s_and_b32 s18, s2, 7
    s_lshl_b32 s88, s18, 10
    s_xor_b32 s89, s88, 0x400
    s_xor_b32 s90, s88, 0x800
    s_xor_b32 s91, s88, 0xc00
    s_xor_b32 s92, s88, 0x1000
    s_xor_b32 s93, s88, 0x1400
    s_xor_b32 s94, s88, 0x1800
    s_xor_b32 s95, s88, 0x1c00
    s_mov_b32 s84, s16
    s_mov_b32 s85, s17
    s_mov_b32 s86, 0x100000
    s_mov_b32 s87, 0x20000
    v_lshl_add_u32 v10, v48, 8, v58
    s_lshl_b32 s18, s33, 10
    s_add_u32 s60, s33, 15
    s_lshl_b32 s61, s33, 21
    s_add_u32 s18, s18, 0x180000
    v_lshl_add_u32 v85, v0, 8, s18
    v_mov_b32 v86, 1
    s_mov_b32 s59, 0x40000
    s_waitcnt vmcnt(12)
    s_barrier
    ds_read_b128 v[60:63], v58 offset:4096
    ds_read_b128 v[64:67], v58 offset:4160
    ds_read_b128 v[68:71], v58 offset:4224
    ds_read_b128 v[72:75], v58 offset:4288
    ds_read_b128 v[20:23], v10 offset:0
    ds_read_b128 v[24:27], v10 offset:64
    ds_read_b128 v[28:31], v10 offset:128
    ds_read_b128 v[32:35], v10 offset:192
    s_waitcnt lgkmcnt(0)
    s_add_u32 s57, s57, 0x9e3779b1
    s_or_b32 s18, s39, s31
    s_cbranch_scc1 L_noinit
    v_mov_b32 v48, 0
    v_mov_b32 v49, s57
    v_mov_b32 v50, 0
    v_mov_b32 v51, 0
    s_mov_b64 exec, 3
    global_store_dwordx4 v85, v[48:51], s[16:17] sc0 sc1
    s_mov_b64 exec, -1
L_noinit:
    s_waitcnt vmcnt(11)
    buffer_load_dwordx4 a[16:19], v2, s[24:27], s69 offen offset:0 nt
    v_lshlrev_b32 v48, 16, v104
    v_and_b32 v49, s36, v104
    v_lshlrev_b32 v50, 16, v105
    v_and_b32 v51, s36, v105
    v_lshlrev_b32 v52, 16, v106
    v_and_b32 v53, s36, v106
    v_lshlrev_b32 v54, 16, v107
    v_and_b32 v55, s36, v107
    v_pk_mul_f32 v[48:49], v[48:49], s[34:35]
    v_pk_mul_f32 v[50:51], v[50:51], s[34:35]
    v_pk_mul_f32 v[52:53], v[52:53], s[34:35]
    v_pk_mul_f32 v[54:55], v[54:55], s[34:35]
    v_cvt_pk_bf16_f32 v104, v48, v49
    v_cvt_pk_bf16_f32 v105, v50, v51
    v_cvt_pk_bf16_f32 v106, v52, v53
    v_cvt_pk_bf16_f32 v107, v54, v55
    s_waitcnt vmcnt(11)
    buffer_load_dwordx4 a[20:23], v2, s[24:27], s69 offen offset:256 nt
    v_lshlrev_b32 v48, 16, v108
    v_and_b32 v49, s36, v108
    v_lshlrev_b32 v50, 16, v109
    v_and_b32 v51, s36, v109
    v_lshlrev_b32 v52, 16, v110
    v_and_b32 v53, s36, v110
    v_lshlrev_b32 v54, 16, v111
    v_and_b32 v55, s36, v111
    v_pk_mul_f32 v[48:49], v[48:49], s[34:35]
    v_pk_mul_f32 v[50:51], v[50:51], s[34:35]
    v_pk_mul_f32 v[52:53], v[52:53], s[34:35]
    v_pk_mul_f32 v[54:55], v[54:55], s[34:35]
    v_cvt_pk_bf16_f32 v108, v48, v49
    v_cvt_pk_bf16_f32 v109, v50, v51
    v_cvt_pk_bf16_f32 v110, v52, v53
    v_cvt_pk_bf16_f32 v111, v54, v55
    v_mfma_f32_16x16x32_bf16 v[40:43], v[104:107], v[104:107], 0
    v_mfma_f32_16x16x32_bf16 v[36:39], v[20:23], v[104:107], 0
    s_waitcnt vmcnt(11)
    buffer_load_dwordx4 a[24:27], v2, s[24:27], s69 offen offset:512 nt
    v_lshlrev_b32 v48, 16, v112
    v_and_b32 v49, s36, v112
    v_lshlrev_b32 v50, 16, v113
    v_and_b32 v51, s36, v113
    v_lshlrev_b32 v52, 16, v114
    v_and_b32 v53, s36, v114
    v_lshlrev_b32 v54, 16, v115
    v_and_b32 v55, s36, v115
    v_pk_mul_f32 v[48:49], v[48:49], s[34:35]
    v_pk_mul_f32 v[50:51], v[50:51], s[34:35]
    v_pk_mul_f32 v[52:53], v[52:53], s[34:35]
    v_pk_mul_f32 v[54:55], v[54:55], s[34:35]
    v_cvt_pk_bf16_f32 v112, v48, v49
    v_cvt_pk_bf16_f32 v113, v50, v51
    v_cvt_pk_bf16_f32 v114, v52, v53
    v_cvt_pk_bf16_f32 v115, v54, v55
    v_mfma_f32_16x16x32_bf16 v[40:43], v[108:111], v[108:111], v[40:43]
    v_mfma_f32_16x16x32_bf16 v[36:39], v[24:27], v[108:111], v[36:39]
    s_waitcnt vmcnt(11)
    buffer_load_dwordx4 a[28:31], v2, s[24:27], s69 offen offset:768 nt
    v_lshlrev_b32 v48, 16, v116
    v_and_b32 v49, s36, v116
    v_lshlrev_b32 v50, 16, v117
    v_and_b32 v51, s36, v117
    v_lshlrev_b32 v52, 16, v118
    v_and_b32 v53, s36, v118
    v_lshlrev_b32 v54, 16, v119
    v_and_b32 v55, s36, v119
    v_pk_mul_f32 v[48:49], v[48:49], s[34:35]
    v_pk_mul_f32 v[50:51], v[50:51], s[34:35]
    v_pk_mul_f32 v[52:53], v[52:53], s[34:35]
    v_pk_mul_f32 v[54:55], v[54:55], s[34:35]
    v_cvt_pk_bf16_f32 v116, v48, v49
    v_cvt_pk_bf16_f32 v117, v50, v51
    v_cvt_pk_bf16_f32 v118, v52, v53
    v_cvt_pk_bf16_f32 v119, v54, v55
    v_mfma_f32_16x16x32_bf16 v[40:43], v[112:115], v[112:115], v[40:43]
    v_mfma_f32_16x16x32_bf16 v[36:39], v[28:31], v[112:115], v[36:39]
    v_mfma_f32_16x16x32_bf16 v[40:43], v[116:119], v[116:119], v[40:43]
    v_mfma_f32_16x16x32_bf16 v[36:39], v[32:35], v[116:119], v[36:39]
    s_nop 6
    v_cndmask_b32 v10, 0, v40, s[48:49]
    v_cndmask_b32 v10, v10, v41, s[50:51]
    v_cndmask_b32 v10, v10, v42, s[52:53]
    v_cndmask_b32 v10, v10, v43, s[54:55]
    s_nop 1
    v_mfma_f32_16x16x4_f32 v[44:47], v3, v10, 0
    v_cvt_pk_bf16_f32 v36, 0, v36
    v_cvt_pk_bf16_f32 v37, 0, v37
    v_cvt_pk_bf16_f32 v38, 0, v38
    v_cvt_pk_bf16_f32 v39, 0, v39
    s_nop 5
    v_cvt_pk_bf16_f32 v11, 0, v44
    v_fma_f32 v36, v11, -0.5, v36
    v_fma_f32 v37, v11, -0.5, v37
    v_fma_f32 v38, v11, -0.5, v38
    v_fma_f32 v39, v11, -0.5, v39
    v_cvt_pk_bf16_f32 v36, 0, v36
    v_cvt_pk_bf16_f32 v37, 0, v37
    v_cvt_pk_bf16_f32 v38, 0, v38
    v_cvt_pk_bf16_f32 v39, 0, v39
    v_fma_f32 v36, v36, s37, -2.0
    v_fma_f32 v37, v37, s37, -2.0
    v_fma_f32 v38, v38, s37, -2.0
    v_fma_f32 v39, v39, s37, -2.0
    v_exp_f32 v36, v36
    v_exp_f32 v37, v37
    v_exp_f32 v38, v38
    v_exp_f32 v39, v39
    v_cvt_pk_bf16_f32 v36, 0, v36
    v_cvt_pk_bf16_f32 v37, 0, v37
    v_cvt_pk_bf16_f32 v38, 0, v38
    v_cvt_pk_bf16_f32 v39, 0, v39
    v_add_f32 v36, s38, v36
    v_add_f32 v37, s38, v37
    v_add_f32 v38, s38, v38
    v_add_f32 v39, s38, v39
    v_cvt_pk_bf16_f32 v56, v36, v37
    v_cvt_pk_bf16_f32 v57, v38, v39
    v_lshlrev_b32 v48, 16, v60
    v_and_b32 v49, s36, v60
    v_lshlrev_b32 v50, 16, v61
    v_and_b32 v51, s36, v61
    v_lshlrev_b32 v52, 16, v62
    v_and_b32 v53, s36, v62
    v_lshlrev_b32 v54, 16, v63
    v_and_b32 v55, s36, v63
    v_pk_mul_f32 v[48:49], v[48:49], s[34:35]
    v_pk_mul_f32 v[50:51], v[50:51], s[34:35]
    v_pk_mul_f32 v[52:53], v[52:53], s[34:35]
    v_pk_mul_f32 v[54:55], v[54:55], s[34:35]
    v_cvt_pk_bf16_f32 v60, v48, v49
    v_cvt_pk_bf16_f32 v61, v50, v51
    v_cvt_pk_bf16_f32 v62, v52, v53
    v_cvt_pk_bf16_f32 v63, v54, v55
    v_lshlrev_b32 v48, 16, v64
    v_and_b32 v49, s36, v64
    v_lshlrev_b32 v50, 16, v65
    v_and_b32 v51, s36, v65
    v_lshlrev_b32 v52, 16, v66
    v_and_b32 v53, s36, v66
    v_lshlrev_b32 v54, 16, v67
    v_and_b32 v55, s36, v67
    v_pk_mul_f32 v[48:49], v[48:49], s[34:35]
    v_pk_mul_f32 v[50:51], v[50:51], s[34:35]
    v_pk_mul_f32 v[52:53], v[52:53], s[34:35]
    v_pk_mul_f32 v[54:55], v[54:55], s[34:35]
    v_cvt_pk_bf16_f32 v64, v48, v49
    v_cvt_pk_bf16_f32 v65, v50, v51
    v_cvt_pk_bf16_f32 v66, v52, v53
    v_cvt_pk_bf16_f32 v67, v54, v55
    v_mfma_f32_16x16x32_bf16 v[40:43], v[60:63], v[60:63], 0
    v_mfma_f32_16x16x32_bf16 v[36:39], v[20:23], v[60:63], 0
    v_lshlrev_b32 v48, 16, v68
    v_and_b32 v49, s36, v68
    v_lshlrev_b32 v50, 16, v69
    v_and_b32 v51, s36, v69
    v_lshlrev_b32 v52, 16, v70
    v_and_b32 v53, s36, v70
    v_lshlrev_b32 v54, 16, v71
    v_and_b32 v55, s36, v71
    v_pk_mul_f32 v[48:49], v[48:49], s[34:35]
    v_pk_mul_f32 v[50:51], v[50:51], s[34:35]
    v_pk_mul_f32 v[52:53], v[52:53], s[34:35]
    v_pk_mul_f32 v[54:55], v[54:55], s[34:35]
    v_cvt_pk_bf16_f32 v68, v48, v49
    v_cvt_pk_bf16_f32 v69, v50, v51
    v_cvt_pk_bf16_f32 v70, v52, v53
    v_cvt_pk_bf16_f32 v71, v54, v55
    v_mfma_f32_16x16x32_bf16 v[40:43], v[64:67], v[64:67], v[40:43]
    v_mfma_f32_16x16x32_bf16 v[36:39], v[24:27], v[64:67], v[36:39]
    v_lshlrev_b32 v48, 16, v72
    v_and_b32 v49, s36, v72
    v_lshlrev_b32 v50, 16, v73
    v_and_b32 v51, s36, v73
    v_lshlrev_b32 v52, 16, v74
    v_and_b32 v53, s36, v74
    v_lshlrev_b32 v54, 16, v75
    v_and_b32 v55, s36, v75
    v_pk_mul_f32 v[48:49], v[48:49], s[34:35]
    v_pk_mul_f32 v[50:51], v[50:51], s[34:35]
    v_pk_mul_f32 v[52:53], v[52:53], s[34:35]
    v_pk_mul_f32 v[54:55], v[54:55], s[34:35]
    v_cvt_pk_bf16_f32 v72, v48, v49
    v_cvt_pk_bf16_f32 v73, v50, v51
    v_cvt_pk_bf16_f32 v74, v52, v53
    v_cvt_pk_bf16_f32 v75, v54, v55
    v_mfma_f32_16x16x32_bf16 v[40:43], v[68:71], v[68:71], v[40:43]
    v_mfma_f32_16x16x32_bf16 v[36:39], v[28:31], v[68:71], v[36:39]
    v_mfma_f32_16x16x32_bf16 v[40:43], v[72:75], v[72:75], v[40:43]
    v_mfma_f32_16x16x32_bf16 v[36:39], v[32:35], v[72:75], v[36:39]
    s_nop 6
    v_cndmask_b32 v10, 0, v40, s[48:49]
    v_cndmask_b32 v10, v10, v41, s[50:51]
    v_cndmask_b32 v10, v10, v42, s[52:53]
    v_cndmask_b32 v10, v10, v43, s[54:55]
    s_nop 1
    v_mfma_f32_16x16x4_f32 v[44:47], v3, v10, 0
    v_cvt_pk_bf16_f32 v36, 0, v36
    v_cvt_pk_bf16_f32 v37, 0, v37
    v_cvt_pk_bf16_f32 v38, 0, v38
    v_cvt_pk_bf16_f32 v39, 0, v39
    s_nop 5
    v_cvt_pk_bf16_f32 v11, 0, v44
    v_fma_f32 v36, v11, -0.5, v36
    v_fma_f32 v37, v11, -0.5, v37
    v_fma_f32 v38, v11, -0.5, v38
    v_fma_f32 v39, v11, -0.5, v39
    v_cvt_pk_bf16_f32 v36, 0, v36
    v_cvt_pk_bf16_f32 v37, 0, v37
    v_cvt_pk_bf16_f32 v38, 0, v38
    v_cvt_pk_bf16_f32 v39, 0, v39
    v_fma_f32 v36, v36, s37, -2.0
    v_fma_f32 v37, v37, s37, -2.0
    v_fma_f32 v38, v38, s37, -2.0
    v_fma_f32 v39, v39, s37, -2.0
    v_exp_f32 v36, v36
    v_exp_f32 v37, v37
    v_exp_f32 v38, v38
    v_exp_f32 v39, v39
    v_cvt_pk_bf16_f32 v36, 0, v36
    v_cvt_pk_bf16_f32 v37, 0, v37
    v_cvt_pk_bf16_f32 v38, 0, v38
    v_cvt_pk_bf16_f32 v39, 0, v39
    v_add_f32 v36, s38, v36
    v_add_f32 v37, s38, v37
    v_add_f32 v38, s38, v38
    v_add_f32 v39, s38, v39
    v_cvt_pk_bf16_f32 v8, v36, v37
    v_cvt_pk_bf16_f32 v9, v38, v39
    s_nop 1
    v_mfma_f32_16x16x16_bf16 v[96:99], v[56:57], v[8:9], 0
    v_mfma_f32_16x16x16_bf16 v[16:19], v[56:57], v[8:9], v[16:19]
    s_nop 6
    v_and_b32 v48, s36, v96
    v_and_b32 v49, s36, v97
    v_and_b32 v50, s36, v98
    v_and_b32 v51, s36, v99
    v_sub_f32 v48, v96, v48
    v_sub_f32 v49, v97, v49
    v_sub_f32 v50, v98, v50
    v_sub_f32 v51, v99, v51
    v_perm_b32 v60, v96, v48, v4
    v_perm_b32 v61, v96, v48, v5
    v_perm_b32 v62, v96, v48, v6
    v_perm_b32 v63, v96, v48, v7
    v_perm_b32 v64, v97, v49, v4
    v_perm_b32 v65, v97, v49, v5
    v_perm_b32 v66, v97, v49, v6
    v_perm_b32 v67, v97, v49, v7
    v_perm_b32 v68, v98, v50, v4
    v_perm_b32 v69, v98, v50, v5
    v_perm_b32 v70, v98, v50, v6
    v_perm_b32 v71, v98, v50, v7
    v_perm_b32 v72, v99, v51, v4
    v_perm_b32 v73, v99, v51, v5
    v_perm_b32 v74, v99, v51, v6
    v_perm_b32 v75, v99, v51, v7
    s_waitcnt vmcnt(11)
    s_add_u32 s56, s56, 131072
    s_and_b32 s56, s56, 2097151
    s_add_u32 s68, s58, s56
    s_add_u32 s65, s65, 0x4000
    s_and_b32 s65, s65, 0x1ffff
    s_add_u32 s68, s68, s65
    buffer_load_dwordx4 v[104:107], v1, s[20:23], s68 offen offset:0 nt
    v_mfma_f32_16x16x32_bf16 v[12:15], v[60:63], a[0:3], v[12:15]
    s_waitcnt vmcnt(11)
    buffer_load_dwordx4 v[108:111], v1, s[20:23], s68 offen offset:64 nt
    v_mfma_f32_16x16x32_bf16 v[12:15], v[64:67], a[4:7], v[12:15]
    s_waitcnt vmcnt(11)
    buffer_load_dwordx4 v[112:115], v1, s[20:23], s68 offen offset:128 nt
    v_mfma_f32_16x16x32_bf16 v[12:15], v[68:71], a[8:11], v[12:15]
    s_waitcnt vmcnt(11)
    buffer_load_dwordx4 v[116:119], v1, s[20:23], s68 offen offset:192 nt
    v_mfma_f32_16x16x32_bf16 v[12:15], v[72:75], a[12:15], v[12:15]
    s_waitcnt vmcnt(11)
    buffer_load_dwordx4 a[0:3], v2, s[24:27], s68 offen offset:0 nt
    v_lshlrev_b32 v48, 16, v120
    v_and_b32 v49, s36, v120
    v_lshlrev_b32 v50, 16, v121
    v_and_b32 v51, s36, v121
    v_lshlrev_b32 v52, 16, v122
    v_and_b32 v53, s36, v122
    v_lshlrev_b32 v54, 16, v123
    v_and_b32 v55, s36, v123
    v_pk_mul_f32 v[48:49], v[48:49], s[34:35]
    v_pk_mul_f32 v[50:51], v[50:51], s[34:35]
    v_pk_mul_f32 v[52:53], v[52:53], s[34:35]
    v_pk_mul_f32 v[54:55], v[54:55], s[34:35]
    v_cvt_pk_bf16_f32 v120, v48, v49
    v_cvt_pk_bf16_f32 v121, v50, v51
    v_cvt_pk_bf16_f32 v122, v52, v53
    v_cvt_pk_bf16_f32 v123, v54, v55
    s_waitcnt vmcnt(11)
    buffer_load_dwordx4 a[4:7], v2, s[24:27], s68 offen offset:256 nt
    v_lshlrev_b32 v48, 16, v124
    v_and_b32 v49, s36, v124
    v_lshlrev_b32 v50, 16, v125
    v_and_b32 v51, s36, v125
    v_lshlrev_b32 v52, 16, v126
    v_and_b32 v53, s36, v126
    v_lshlrev_b32 v54, 16, v127
    v_and_b32 v55, s36, v127
    v_pk_mul_f32 v[48:49], v[48:49], s[34:35]
    v_pk_mul_f32 v[50:51], v[50:51], s[34:35]
    v_pk_mul_f32 v[52:53], v[52:53], s[34:35]
    v_pk_mul_f32 v[54:55], v[54:55], s[34:35]
    v_cvt_pk_bf16_f32 v124, v48, v49
    v_cvt_pk_bf16_f32 v125, v50, v51
    v_cvt_pk_bf16_f32 v126, v52, v53
    v_cvt_pk_bf16_f32 v127, v54, v55
    v_mfma_f32_16x16x32_bf16 v[40:43], v[120:123], v[120:123], 0
    v_mfma_f32_16x16x32_bf16 v[36:39], v[20:23], v[120:123], 0
    s_waitcnt vmcnt(11)
    buffer_load_dwordx4 a[8:11], v2, s[24:27], s68 offen offset:512 nt
    v_lshlrev_b32 v48, 16, v128
    v_and_b32 v49, s36, v128
    v_lshlrev_b32 v50, 16, v129
    v_and_b32 v51, s36, v129
    v_lshlrev_b32 v52, 16, v130
    v_and_b32 v53, s36, v130
    v_lshlrev_b32 v54, 16, v131
    v_and_b32 v55, s36, v131
    v_pk_mul_f32 v[48:49], v[48:49], s[34:35]
    v_pk_mul_f32 v[50:51], v[50:51], s[34:35]
    v_pk_mul_f32 v[52:53], v[52:53], s[34:35]
    v_pk_mul_f32 v[54:55], v[54:55], s[34:35]
    v_cvt_pk_bf16_f32 v128, v48, v49
    v_cvt_pk_bf16_f32 v129, v50, v51
    v_cvt_pk_bf16_f32 v130, v52, v53
    v_cvt_pk_bf16_f32 v131, v54, v55
    v_mfma_f32_16x16x32_bf16 v[40:43], v[124:127], v[124:127], v[40:43]
    v_mfma_f32_16x16x32_bf16 v[36:39], v[24:27], v[124:127], v[36:39]
    s_waitcnt vmcnt(11)
    buffer_load_dwordx4 a[12:15], v2, s[24:27], s68 offen offset:768 nt
    v_lshlrev_b32 v48, 16, v132
    v_and_b32 v49, s36, v132
    v_lshlrev_b32 v50, 16, v133
    v_and_b32 v51, s36, v133
    v_lshlrev_b32 v52, 16, v134
    v_and_b32 v53, s36, v134
    v_lshlrev_b32 v54, 16, v135
    v_and_b32 v55, s36, v135
    v_pk_mul_f32 v[48:49], v[48:49], s[34:35]
    v_pk_mul_f32 v[50:51], v[50:51], s[34:35]
    v_pk_mul_f32 v[52:53], v[52:53], s[34:35]
    v_pk_mul_f32 v[54:55], v[54:55], s[34:35]
    v_cvt_pk_bf16_f32 v132, v48, v49
    v_cvt_pk_bf16_f32 v133, v50, v51
    v_cvt_pk_bf16_f32 v134, v52, v53
    v_cvt_pk_bf16_f32 v135, v54, v55
    v_mfma_f32_16x16x32_bf16 v[40:43], v[128:131], v[128:131], v[40:43]
    v_mfma_f32_16x16x32_bf16 v[36:39], v[28:31], v[128:131], v[36:39]
    v_mfma_f32_16x16x32_bf16 v[40:43], v[132:135], v[132:135], v[40:43]
    v_mfma_f32_16x16x32_bf16 v[36:39], v[32:35], v[132:135], v[36:39]
    s_nop 6
    v_cndmask_b32 v10, 0, v40, s[48:49]
    v_cndmask_b32 v10, v10, v41, s[50:51]
    v_cndmask_b32 v10, v10, v42, s[52:53]
    v_cndmask_b32 v10, v10, v43, s[54:55]
    s_nop 1
    v_mfma_f32_16x16x4_f32 v[44:47], v3, v10, 0
    v_cvt_pk_bf16_f32 v36, 0, v36
    v_cvt_pk_bf16_f32 v37, 0, v37
    v_cvt_pk_bf16_f32 v38, 0, v38
    v_cvt_pk_bf16_f32 v39, 0, v39
    s_nop 5
    v_cvt_pk_bf16_f32 v11, 0, v44
    v_fma_f32 v36, v11, -0.5, v36
    v_fma_f32 v37, v11, -0.5, v37
    v_fma_f32 v38, v11, -0.5, v38
    v_fma_f32 v39, v11, -0.5, v39
    v_cvt_pk_bf16_f32 v36, 0, v36
    v_cvt_pk_bf16_f32 v37, 0, v37
    v_cvt_pk_bf16_f32 v38, 0, v38
    v_cvt_pk_bf16_f32 v39, 0, v39
    v_fma_f32 v36, v36, s37, -2.0
    v_fma_f32 v37, v37, s37, -2.0
    v_fma_f32 v38, v38, s37, -2.0
    v_fma_f32 v39, v39, s37, -2.0
    v_exp_f32 v36, v36
    v_exp_f32 v37, v37
    v_exp_f32 v38, v38
    v_exp_f32 v39, v39
    v_cvt_pk_bf16_f32 v36, 0, v36
    v_cvt_pk_bf16_f32 v37, 0, v37
    v_cvt_pk_bf16_f32 v38, 0, v38
    v_cvt_pk_bf16_f32 v39, 0, v39
    v_add_f32 v36, s38, v36
    v_add_f32 v37, s38, v37
    v_add_f32 v38, s38, v38
    v_add_f32 v39, s38, v39
    v_cvt_pk_bf16_f32 v56, v36, v37
    v_cvt_pk_bf16_f32 v57, v38, v39
    s_nop 1
    v_mfma_f32_16x16x16_bf16 v[100:103], v[56:57], v[8:9], 0
    v_mfma_f32_16x16x16_bf16 v[16:19], v[56:57], v[8:9], v[16:19]
    s_nop 6
    v_and_b32 v48, s36, v100
    v_and_b32 v49, s36, v101
    v_and_b32 v50, s36, v102
    v_and_b32 v51, s36, v103
    v_sub_f32 v48, v100, v48
    v_sub_f32 v49, v101, v49
    v_sub_f32 v50, v102, v50
    v_sub_f32 v51, v103, v51
    v_perm_b32 v60, v100, v48, v4
    v_perm_b32 v61, v100, v48, v5
    v_perm_b32 v62, v100, v48, v6
    v_perm_b32 v63, v100, v48, v7
    v_perm_b32 v64, v101, v49, v4
    v_perm_b32 v65, v101, v49, v5
    v_perm_b32 v66, v101, v49, v6
    v_perm_b32 v67, v101, v49, v7
    v_perm_b32 v68, v102, v50, v4
    v_perm_b32 v69, v102, v50, v5
    v_perm_b32 v70, v102, v50, v6
    v_perm_b32 v71, v102, v50, v7
    v_perm_b32 v72, v103, v51, v4
    v_perm_b32 v73, v103, v51, v5
    v_perm_b32 v74, v103, v51, v6
    v_perm_b32 v75, v103, v51, v7
    s_waitcnt vmcnt(11)
    s_add_u32 s56, s56, 131072
    s_and_b32 s56, s56, 2097151
    s_add_u32 s69, s58, s56
    s_add_u32 s65, s65, 0x4000
    s_and_b32 s65, s65, 0x1ffff
    s_add_u32 s69, s69, s65
    buffer_load_dwordx4 v[120:123], v1, s[20:23], s69 offen offset:0 nt
    v_mfma_f32_16x16x32_bf16 v[12:15], v[60:63], a[16:19], v[12:15]
    s_waitcnt vmcnt(11)
    buffer_load_dwordx4 v[124:127], v1, s[20:23], s69 offen offset:64 nt
    v_mfma_f32_16x16x32_bf16 v[12:15], v[64:67], a[20:23], v[12:15]
    s_waitcnt vmcnt(11)
    buffer_load_dwordx4 v[128:131], v1, s[20:23], s69 offen offset:128 nt
    v_mfma_f32_16x16x32_bf16 v[12:15], v[68:71], a[24:27], v[12:15]
    s_waitcnt vmcnt(11)
    buffer_load_dwordx4 v[132:135], v1, s[20:23], s69 offen offset:192 nt
    v_mfma_f32_16x16x32_bf16 v[12:15], v[72:75], a[28:31], v[12:15]
    s_waitcnt vmcnt(11)
    buffer_load_dwordx4 a[16:19], v2, s[24:27], s69 offen offset:0 nt
    v_lshlrev_b32 v48, 16, v104
    v_and_b32 v49, s36, v104
    v_lshlrev_b32 v50, 16, v105
    v_and_b32 v51, s36, v105
    v_lshlrev_b32 v52, 16, v106
    v_and_b32 v53, s36, v106
    v_lshlrev_b32 v54, 16, v107
    v_and_b32 v55, s36, v107
    v_pk_mul_f32 v[48:49], v[48:49], s[34:35]
    v_pk_mul_f32 v[50:51], v[50:51], s[34:35]
    v_pk_mul_f32 v[52:53], v[52:53], s[34:35]
    v_pk_mul_f32 v[54:55], v[54:55], s[34:35]
    v_cvt_pk_bf16_f32 v104, v48, v49
    v_cvt_pk_bf16_f32 v105, v50, v51
    v_cvt_pk_bf16_f32 v106, v52, v53
    v_cvt_pk_bf16_f32 v107, v54, v55
    s_waitcnt vmcnt(11)
    buffer_load_dwordx4 a[20:23], v2, s[24:27], s69 offen offset:256 nt
    v_lshlrev_b32 v48, 16, v108
    v_and_b32 v49, s36, v108
    v_lshlrev_b32 v50, 16, v109
    v_and_b32 v51, s36, v109
    v_lshlrev_b32 v52, 16, v110
    v_and_b32 v53, s36, v110
    v_lshlrev_b32 v54, 16, v111
    v_and_b32 v55, s36, v111
    v_pk_mul_f32 v[48:49], v[48:49], s[34:35]
    v_pk_mul_f32 v[50:51], v[50:51], s[34:35]
    v_pk_mul_f32 v[52:53], v[52:53], s[34:35]
    v_pk_mul_f32 v[54:55], v[54:55], s[34:35]
    v_cvt_pk_bf16_f32 v108, v48, v49
    v_cvt_pk_bf16_f32 v109, v50, v51
    v_cvt_pk_bf16_f32 v110, v52, v53
    v_cvt_pk_bf16_f32 v111, v54, v55
    v_mfma_f32_16x16x32_bf16 v[40:43], v[104:107], v[104:107], 0
    v_mfma_f32_16x16x32_bf16 v[36:39], v[20:23], v[104:107], 0
    s_waitcnt vmcnt(11)
    buffer_load_dwordx4 a[24:27], v2, s[24:27], s69 offen offset:512 nt
    v_lshlrev_b32 v48, 16, v112
    v_and_b32 v49, s36, v112
    v_lshlrev_b32 v50, 16, v113
    v_and_b32 v51, s36, v113
    v_lshlrev_b32 v52, 16, v114
    v_and_b32 v53, s36, v114
    v_lshlrev_b32 v54, 16, v115
    v_and_b32 v55, s36, v115
    v_pk_mul_f32 v[48:49], v[48:49], s[34:35]
    v_pk_mul_f32 v[50:51], v[50:51], s[34:35]
    v_pk_mul_f32 v[52:53], v[52:53], s[34:35]
    v_pk_mul_f32 v[54:55], v[54:55], s[34:35]
    v_cvt_pk_bf16_f32 v112, v48, v49
    v_cvt_pk_bf16_f32 v113, v50, v51
    v_cvt_pk_bf16_f32 v114, v52, v53
    v_cvt_pk_bf16_f32 v115, v54, v55
    v_mfma_f32_16x16x32_bf16 v[40:43], v[108:111], v[108:111], v[40:43]
    v_mfma_f32_16x16x32_bf16 v[36:39], v[24:27], v[108:111], v[36:39]
    s_waitcnt vmcnt(11)
    buffer_load_dwordx4 a[28:31], v2, s[24:27], s69 offen offset:768 nt
    v_lshlrev_b32 v48, 16, v116
    v_and_b32 v49, s36, v116
    v_lshlrev_b32 v50, 16, v117
    v_and_b32 v51, s36, v117
    v_lshlrev_b32 v52, 16, v118
    v_and_b32 v53, s36, v118
    v_lshlrev_b32 v54, 16, v119
    v_and_b32 v55, s36, v119
    v_pk_mul_f32 v[48:49], v[48:49], s[34:35]
    v_pk_mul_f32 v[50:51], v[50:51], s[34:35]
    v_pk_mul_f32 v[52:53], v[52:53], s[34:35]
    v_pk_mul_f32 v[54:55], v[54:55], s[34:35]
    v_cvt_pk_bf16_f32 v116, v48, v49
    v_cvt_pk_bf16_f32 v117, v50, v51
    v_cvt_pk_bf16_f32 v118, v52, v53
    v_cvt_pk_bf16_f32 v119, v54, v55
    v_mfma_f32_16x16x32_bf16 v[40:43], v[112:115], v[112:115], v[40:43]
    v_mfma_f32_16x16x32_bf16 v[36:39], v[28:31], v[112:115], v[36:39]
    v_mfma_f32_16x16x32_bf16 v[40:43], v[116:119], v[116:119], v[40:43]
    v_mfma_f32_16x16x32_bf16 v[36:39], v[32:35], v[116:119], v[36:39]
    s_nop 6
    v_cndmask_b32 v10, 0, v40, s[48:49]
    v_cndmask_b32 v10, v10, v41, s[50:51]
    v_cndmask_b32 v10, v10, v42, s[52:53]
    v_cndmask_b32 v10, v10, v43, s[54:55]
    s_nop 1
    v_mfma_f32_16x16x4_f32 v[44:47], v3, v10, 0
    v_cvt_pk_bf16_f32 v36, 0, v36
    v_cvt_pk_bf16_f32 v37, 0, v37
    v_cvt_pk_bf16_f32 v38, 0, v38
    v_cvt_pk_bf16_f32 v39, 0, v39
    s_nop 5
    v_cvt_pk_bf16_f32 v11, 0, v44
    v_fma_f32 v36, v11, -0.5, v36
    v_fma_f32 v37, v11, -0.5, v37
    v_fma_f32 v38, v11, -0.5, v38
    v_fma_f32 v39, v11, -0.5, v39
    v_cvt_pk_bf16_f32 v36, 0, v36
    v_cvt_pk_bf16_f32 v37, 0, v37
    v_cvt_pk_bf16_f32 v38, 0, v38
    v_cvt_pk_bf16_f32 v39, 0, v39
    v_fma_f32 v36, v36, s37, -2.0
    v_fma_f32 v37, v37, s37, -2.0
    v_fma_f32 v38, v38, s37, -2.0
    v_fma_f32 v39, v39, s37, -2.0
    v_exp_f32 v36, v36
    v_exp_f32 v37, v37
    v_exp_f32 v38, v38
    v_exp_f32 v39, v39
    v_cvt_pk_bf16_f32 v36, 0, v36
    v_cvt_pk_bf16_f32 v37, 0, v37
    v_cvt_pk_bf16_f32 v38, 0, v38
    v_cvt_pk_bf16_f32 v39, 0, v39
    v_add_f32 v36, s38, v36
    v_add_f32 v37, s38, v37
    v_add_f32 v38, s38, v38
    v_add_f32 v39, s38, v39
    v_cvt_pk_bf16_f32 v56, v36, v37
    v_cvt_pk_bf16_f32 v57, v38, v39
    s_nop 1
    v_mfma_f32_16x16x16_bf16 v[96:99], v[56:57], v[8:9], 0
    v_mfma_f32_16x16x16_bf16 v[16:19], v[56:57], v[8:9], v[16:19]
    s_nop 6
    v_and_b32 v48, s36, v96
    v_and_b32 v49, s36, v97
    v_and_b32 v50, s36, v98
    v_and_b32 v51, s36, v99
    v_sub_f32 v48, v96, v48
    v_sub_f32 v49, v97, v49
    v_sub_f32 v50, v98, v50
    v_sub_f32 v51, v99, v51
    v_perm_b32 v60, v96, v48, v4
    v_perm_b32 v61, v96, v48, v5
    v_perm_b32 v62, v96, v48, v6
    v_perm_b32 v63, v96, v48, v7
    v_perm_b32 v64, v97, v49, v4
    v_perm_b32 v65, v97, v49, v5
    v_perm_b32 v66, v97, v49, v6
    v_perm_b32 v67, v97, v49, v7
    v_perm_b32 v68, v98, v50, v4
    v_perm_b32 v69, v98, v50, v5
    v_perm_b32 v70, v98, v50, v6
    v_perm_b32 v71, v98, v50, v7
    v_perm_b32 v72, v99, v51, v4
    v_perm_b32 v73, v99, v51, v5
    v_perm_b32 v74, v99, v51, v6
    v_perm_b32 v75, v99, v51, v7
    s_waitcnt vmcnt(11)
    s_add_u32 s56, s56, 131072
    s_and_b32 s56, s56, 2097151
    s_add_u32 s68, s58, s56
    s_add_u32 s65, s65, 0x4000
    s_and_b32 s65, s65, 0x1ffff
    s_add_u32 s68, s68, s65
    buffer_load_dwordx4 v[104:107], v1, s[20:23], s68 offen offset:0 nt
    v_mfma_f32_16x16x32_bf16 v[12:15], v[60:63], a[0:3], v[12:15]
    s_waitcnt vmcnt(11)
    buffer_load_dwordx4 v[108:111], v1, s[20:23], s68 offen offset:64 nt
    v_mfma_f32_16x16x32_bf16 v[12:15], v[64:67], a[4:7], v[12:15]
    s_waitcnt vmcnt(11)
    buffer_load_dwordx4 v[112:115], v1, s[20:23], s68 offen offset:128 nt
    v_mfma_f32_16x16x32_bf16 v[12:15], v[68:71], a[8:11], v[12:15]
    s_waitcnt vmcnt(11)
    buffer_load_dwordx4 v[116:119], v1, s[20:23], s68 offen offset:192 nt
    v_mfma_f32_16x16x32_bf16 v[12:15], v[72:75], a[12:15], v[12:15]
    global_load_dword v59, v83, s[12:13]
    s_waitcnt vmcnt(12)
    buffer_load_dwordx4 a[0:3], v2, s[24:27], s68 offen offset:0 nt
    v_lshlrev_b32 v48, 16, v120
    v_and_b32 v49, s36, v120
    v_lshlrev_b32 v50, 16, v121
    v_and_b32 v51, s36, v121
    v_lshlrev_b32 v52, 16, v122
    v_and_b32 v53, s36, v122
    v_lshlrev_b32 v54, 16, v123
    v_and_b32 v55, s36, v123
    v_pk_mul_f32 v[48:49], v[48:49], s[34:35]
    v_pk_mul_f32 v[50:51], v[50:51], s[34:35]
    v_pk_mul_f32 v[52:53], v[52:53], s[34:35]
    v_pk_mul_f32 v[54:55], v[54:55], s[34:35]
    v_cvt_pk_bf16_f32 v120, v48, v49
    v_cvt_pk_bf16_f32 v121, v50, v51
    v_cvt_pk_bf16_f32 v122, v52, v53
    v_cvt_pk_bf16_f32 v123, v54, v55
    s_waitcnt vmcnt(12)
    buffer_load_dwordx4 a[4:7], v2, s[24:27], s68 offen offset:256 nt
    v_lshlrev_b32 v48, 16, v124
    v_and_b32 v49, s36, v124
    v_lshlrev_b32 v50, 16, v125
    v_and_b32 v51, s36, v125
    v_lshlrev_b32 v52, 16, v126
    v_and_b32 v53, s36, v126
    v_lshlrev_b32 v54, 16, v127
    v_and_b32 v55, s36, v127
    v_pk_mul_f32 v[48:49], v[48:49], s[34:35]
    v_pk_mul_f32 v[50:51], v[50:51], s[34:35]
    v_pk_mul_f32 v[52:53], v[52:53], s[34:35]
    v_pk_mul_f32 v[54:55], v[54:55], s[34:35]
    v_cvt_pk_bf16_f32 v124, v48, v49
    v_cvt_pk_bf16_f32 v125, v50, v51
    v_cvt_pk_bf16_f32 v126, v52, v53
    v_cvt_pk_bf16_f32 v127, v54, v55
    v_mfma_f32_16x16x32_bf16 v[40:43], v[120:123], v[120:123], 0
    v_mfma_f32_16x16x32_bf16 v[36:39], v[20:23], v[120:123], 0
    s_waitcnt vmcnt(12)
    buffer_load_dwordx4 a[8:11], v2, s[24:27], s68 offen offset:512 nt
    v_lshlrev_b32 v48, 16, v128
    v_and_b32 v49, s36, v128
    v_lshlrev_b32 v50, 16, v129
    v_and_b32 v51, s36, v129
    v_lshlrev_b32 v52, 16, v130
    v_and_b32 v53, s36, v130
    v_lshlrev_b32 v54, 16, v131
    v_and_b32 v55, s36, v131
    v_pk_mul_f32 v[48:49], v[48:49], s[34:35]
    v_pk_mul_f32 v[50:51], v[50:51], s[34:35]
    v_pk_mul_f32 v[52:53], v[52:53], s[34:35]
    v_pk_mul_f32 v[54:55], v[54:55], s[34:35]
    v_cvt_pk_bf16_f32 v128, v48, v49
    v_cvt_pk_bf16_f32 v129, v50, v51
    v_cvt_pk_bf16_f32 v130, v52, v53
    v_cvt_pk_bf16_f32 v131, v54, v55
    v_mfma_f32_16x16x32_bf16 v[40:43], v[124:127], v[124:127], v[40:43]
    v_mfma_f32_16x16x32_bf16 v[36:39], v[24:27], v[124:127], v[36:39]
    s_waitcnt vmcnt(12)
    buffer_load_dwordx4 a[12:15], v2, s[24:27], s68 offen offset:768 nt
    v_lshlrev_b32 v48, 16, v132
    v_and_b32 v49, s36, v132
    v_lshlrev_b32 v50, 16, v133
    v_and_b32 v51, s36, v133
    v_lshlrev_b32 v52, 16, v134
    v_and_b32 v53, s36, v134
    v_lshlrev_b32 v54, 16, v135
    v_and_b32 v55, s36, v135
    v_pk_mul_f32 v[48:49], v[48:49], s[34:35]
    v_pk_mul_f32 v[50:51], v[50:51], s[34:35]
    v_pk_mul_f32 v[52:53], v[52:53], s[34:35]
    v_pk_mul_f32 v[54:55], v[54:55], s[34:35]
    v_cvt_pk_bf16_f32 v132, v48, v49
    v_cvt_pk_bf16_f32 v133, v50, v51
    v_cvt_pk_bf16_f32 v134, v52, v53
    v_cvt_pk_bf16_f32 v135, v54, v55
    v_mfma_f32_16x16x32_bf16 v[40:43], v[128:131], v[128:131], v[40:43]
    v_mfma_f32_16x16x32_bf16 v[36:39], v[28:31], v[128:131], v[36:39]
    v_mfma_f32_16x16x32_bf16 v[40:43], v[132:135], v[132:135], v[40:43]
    v_mfma_f32_16x16x32_bf16 v[36:39], v[32:35], v[132:135], v[36:39]
    s_nop 6
    v_cndmask_b32 v10, 0, v40, s[48:49]
    v_cndmask_b32 v10, v10, v41, s[50:51]
    v_cndmask_b32 v10, v10, v42, s[52:53]
    v_cndmask_b32 v10, v10, v43, s[54:55]
    s_nop 1
    v_mfma_f32_16x16x4_f32 v[44:47], v3, v10, 0
    v_cvt_pk_bf16_f32 v36, 0, v36
    v_cvt_pk_bf16_f32 v37, 0, v37
    v_cvt_pk_bf16_f32 v38, 0, v38
    v_cvt_pk_bf16_f32 v39, 0, v39
    s_nop 5
    v_cvt_pk_bf16_f32 v11, 0, v44
    v_fma_f32 v36, v11, -0.5, v36
    v_fma_f32 v37, v11, -0.5, v37
    v_fma_f32 v38, v11, -0.5, v38
    v_fma_f32 v39, v11, -0.5, v39
    v_cvt_pk_bf16_f32 v36, 0, v36
    v_cvt_pk_bf16_f32 v37, 0, v37
    v_cvt_pk_bf16_f32 v38, 0, v38
    v_cvt_pk_bf16_f32 v39, 0, v39
    v_fma_f32 v36, v36, s37, -2.0
    v_fma_f32 v37, v37, s37, -2.0
    v_fma_f32 v38, v38, s37, -2.0
    v_fma_f32 v39, v39, s37, -2.0
    v_exp_f32 v36, v36
    v_exp_f32 v37, v37
    v_exp_f32 v38, v38
    v_exp_f32 v39, v39
    v_cvt_pk_bf16_f32 v36, 0, v36
    v_cvt_pk_bf16_f32 v37, 0, v37
    v_cvt_pk_bf16_f32 v38, 0, v38
    v_cvt_pk_bf16_f32 v39, 0, v39
    v_add_f32 v36, s38, v36
    v_add_f32 v37, s38, v37
    v_add_f32 v38, s38, v38
    v_add_f32 v39, s38, v39
    v_cvt_pk_bf16_f32 v56, v36, v37
    v_cvt_pk_bf16_f32 v57, v38, v39
    s_nop 1
    v_mfma_f32_16x16x16_bf16 v[100:103], v[56:57], v[8:9], 0
    v_mfma_f32_16x16x16_bf16 v[16:19], v[56:57], v[8:9], v[16:19]
    s_nop 6
    v_and_b32 v48, s36, v100
    v_and_b32 v49, s36, v101
    v_and_b32 v50, s36, v102
    v_and_b32 v51, s36, v103
    v_sub_f32 v48, v100, v48
    v_sub_f32 v49, v101, v49
    v_sub_f32 v50, v102, v50
    v_sub_f32 v51, v103, v51
    v_perm_b32 v60, v100, v48, v4
    v_perm_b32 v61, v100, v48, v5
    v_perm_b32 v62, v100, v48, v6
    v_perm_b32 v63, v100, v48, v7
    v_perm_b32 v64, v101, v49, v4
    v_perm_b32 v65, v101, v49, v5
    v_perm_b32 v66, v101, v49, v6
    v_perm_b32 v67, v101, v49, v7
    v_perm_b32 v68, v102, v50, v4
    v_perm_b32 v69, v102, v50, v5
    v_perm_b32 v70, v102, v50, v6
    v_perm_b32 v71, v102, v50, v7
    v_perm_b32 v72, v103, v51, v4
    v_perm_b32 v73, v103, v51, v5
    v_perm_b32 v74, v103, v51, v6
    v_perm_b32 v75, v103, v51, v7
    s_waitcnt vmcnt(12)
    s_add_u32 s56, s56, 131072
    s_and_b32 s56, s56, 2097151
    s_add_u32 s69, s58, s56
    s_add_u32 s65, s65, 0x4000
    s_and_b32 s65, s65, 0x1ffff
    s_add_u32 s69, s69, s65
    buffer_load_dwordx4 v[120:123], v1, s[20:23], s69 offen offset:0 nt
    v_mfma_f32_16x16x32_bf16 v[12:15], v[60:63], a[16:19], v[12:15]
    s_waitcnt vmcnt(12)
    buffer_load_dwordx4 v[124:127], v1, s[20:23], s69 offen offset:64 nt
    v_mfma_f32_16x16x32_bf16 v[12:15], v[64:67], a[20:23], v[12:15]
    s_waitcnt vmcnt(12)
    buffer_load_dwordx4 v[128:131], v1, s[20:23], s69 offen offset:128 nt
    v_mfma_f32_16x16x32_bf16 v[12:15], v[68:71], a[24:27], v[12:15]
    s_waitcnt vmcnt(12)
    buffer_load_dwordx4 v[132:135], v1, s[20:23], s69 offen offset:192 nt
    v_mfma_f32_16x16x32_bf16 v[12:15], v[72:75], a[28:31], v[12:15]
    s_waitcnt vmcnt(12)
    buffer_load_dwordx4 a[16:19], v2, s[24:27], s69 offen offset:0 nt
    v_lshlrev_b32 v48, 16, v104
    v_and_b32 v49, s36, v104
    v_lshlrev_b32 v50, 16, v105
    v_and_b32 v51, s36, v105
    v_lshlrev_b32 v52, 16, v106
    v_and_b32 v53, s36, v106
    v_lshlrev_b32 v54, 16, v107
    v_and_b32 v55, s36, v107
    v_pk_mul_f32 v[48:49], v[48:49], s[34:35]
    v_pk_mul_f32 v[50:51], v[50:51], s[34:35]
    v_pk_mul_f32 v[52:53], v[52:53], s[34:35]
    v_pk_mul_f32 v[54:55], v[54:55], s[34:35]
    v_cvt_pk_bf16_f32 v104, v48, v49
    v_cvt_pk_bf16_f32 v105, v50, v51
    v_cvt_pk_bf16_f32 v106, v52, v53
    v_cvt_pk_bf16_f32 v107, v54, v55
    s_waitcnt vmcnt(12)
    buffer_load_dwordx4 a[20:23], v2, s[24:27], s69 offen offset:256 nt
    v_lshlrev_b32 v48, 16, v108
    v_and_b32 v49, s36, v108
    v_lshlrev_b32 v50, 16, v109
    v_and_b32 v51, s36, v109
    v_lshlrev_b32 v52, 16, v110
    v_and_b32 v53, s36, v110
    v_lshlrev_b32 v54, 16, v111
    v_and_b32 v55, s36, v111
    v_pk_mul_f32 v[48:49], v[48:49], s[34:35]
    v_pk_mul_f32 v[50:51], v[50:51], s[34:35]
    v_pk_mul_f32 v[52:53], v[52:53], s[34:35]
    v_pk_mul_f32 v[54:55], v[54:55], s[34:35]
    v_cvt_pk_bf16_f32 v108, v48, v49
    v_cvt_pk_bf16_f32 v109, v50, v51
    v_cvt_pk_bf16_f32 v110, v52, v53
    v_cvt_pk_bf16_f32 v111, v54, v55
    v_mfma_f32_16x16x32_bf16 v[40:43], v[104:107], v[104:107], 0
    v_mfma_f32_16x16x32_bf16 v[36:39], v[20:23], v[104:107], 0
    s_waitcnt vmcnt(12)
    buffer_load_dwordx4 a[24:27], v2, s[24:27], s69 offen offset:512 nt
    v_lshlrev_b32 v48, 16, v112
    v_and_b32 v49, s36, v112
    v_lshlrev_b32 v50, 16, v113
    v_and_b32 v51, s36, v113
    v_lshlrev_b32 v52, 16, v114
    v_and_b32 v53, s36, v114
    v_lshlrev_b32 v54, 16, v115
    v_and_b32 v55, s36, v115
    v_pk_mul_f32 v[48:49], v[48:49], s[34:35]
    v_pk_mul_f32 v[50:51], v[50:51], s[34:35]
    v_pk_mul_f32 v[52:53], v[52:53], s[34:35]
    v_pk_mul_f32 v[54:55], v[54:55], s[34:35]
    v_cvt_pk_bf16_f32 v112, v48, v49
    v_cvt_pk_bf16_f32 v113, v50, v51
    v_cvt_pk_bf16_f32 v114, v52, v53
    v_cvt_pk_bf16_f32 v115, v54, v55
    v_mfma_f32_16x16x32_bf16 v[40:43], v[108:111], v[108:111], v[40:43]
    v_mfma_f32_16x16x32_bf16 v[36:39], v[24:27], v[108:111], v[36:39]
    s_waitcnt vmcnt(12)
    buffer_load_dwordx4 a[28:31], v2, s[24:27], s69 offen offset:768 nt
    v_lshlrev_b32 v48, 16, v116
    v_and_b32 v49, s36, v116
    v_lshlrev_b32 v50, 16, v117
    v_and_b32 v51, s36, v117
    v_lshlrev_b32 v52, 16, v118
    v_and_b32 v53, s36, v118
    v_lshlrev_b32 v54, 16, v119
    v_and_b32 v55, s36, v119
    v_pk_mul_f32 v[48:49], v[48:49], s[34:35]
    v_pk_mul_f32 v[50:51], v[50:51], s[34:35]
    v_pk_mul_f32 v[52:53], v[52:53], s[34:35]
    v_pk_mul_f32 v[54:55], v[54:55], s[34:35]
    v_cvt_pk_bf16_f32 v116, v48, v49
    v_cvt_pk_bf16_f32 v117, v50, v51
    v_cvt_pk_bf16_f32 v118, v52, v53
    v_cvt_pk_bf16_f32 v119, v54, v55
    v_mfma_f32_16x16x32_bf16 v[40:43], v[112:115], v[112:115], v[40:43]
    v_mfma_f32_16x16x32_bf16 v[36:39], v[28:31], v[112:115], v[36:39]
    v_mfma_f32_16x16x32_bf16 v[40:43], v[116:119], v[116:119], v[40:43]
    v_mfma_f32_16x16x32_bf16 v[36:39], v[32:35], v[116:119], v[36:39]
    s_nop 6
    v_cndmask_b32 v10, 0, v40, s[48:49]
    v_cndmask_b32 v10, v10, v41, s[50:51]
    v_cndmask_b32 v10, v10, v42, s[52:53]
    v_cndmask_b32 v10, v10, v43, s[54:55]
    s_nop 1
    v_mfma_f32_16x16x4_f32 v[44:47], v3, v10, 0
    v_cvt_pk_bf16_f32 v36, 0, v36
    v_cvt_pk_bf16_f32 v37, 0, v37
    v_cvt_pk_bf16_f32 v38, 0, v38
    v_cvt_pk_bf16_f32 v39, 0, v39
    s_nop 5
    v_cvt_pk_bf16_f32 v11, 0, v44
    v_fma_f32 v36, v11, -0.5, v36
    v_fma_f32 v37, v11, -0.5, v37
    v_fma_f32 v38, v11, -0.5, v38
    v_fma_f32 v39, v11, -0.5, v39
    v_cvt_pk_bf16_f32 v36, 0, v36
    v_cvt_pk_bf16_f32 v37, 0, v37
    v_cvt_pk_bf16_f32 v38, 0, v38
    v_cvt_pk_bf16_f32 v39, 0, v39
    v_fma_f32 v36, v36, s37, -2.0
    v_fma_f32 v37, v37, s37, -2.0
    v_fma_f32 v38, v38, s37, -2.0
    v_fma_f32 v39, v39, s37, -2.0
    v_exp_f32 v36, v36
    v_exp_f32 v37, v37
    v_exp_f32 v38, v38
    v_exp_f32 v39, v39
    v_cvt_pk_bf16_f32 v36, 0, v36
    v_cvt_pk_bf16_f32 v37, 0, v37
    v_cvt_pk_bf16_f32 v38, 0, v38
    v_cvt_pk_bf16_f32 v39, 0, v39
    v_add_f32 v36, s38, v36
    v_add_f32 v37, s38, v37
    v_add_f32 v38, s38, v38
    v_add_f32 v39, s38, v39
    v_cvt_pk_bf16_f32 v56, v36, v37
    v_cvt_pk_bf16_f32 v57, v38, v39
    s_nop 1
    v_mfma_f32_16x16x16_bf16 v[96:99], v[56:57], v[8:9], 0
    v_mfma_f32_16x16x16_bf16 v[16:19], v[56:57], v[8:9], v[16:19]
    s_nop 6
    v_and_b32 v48, s36, v96
    v_and_b32 v49, s36, v97
    v_and_b32 v50, s36, v98
    v_and_b32 v51, s36, v99
    v_sub_f32 v48, v96, v48
    v_sub_f32 v49, v97, v49
    v_sub_f32 v50, v98, v50
    v_sub_f32 v51, v99, v51
    v_perm_b32 v60, v96, v48, v4
    v_perm_b32 v61, v96, v48, v5
    v_perm_b32 v62, v96, v48, v6
    v_perm_b32 v63, v96, v48, v7
    v_perm_b32 v64, v97, v49, v4
    v_perm_b32 v65, v97, v49, v5
    v_perm_b32 v66, v97, v49, v6
    v_perm_b32 v67, v97, v49, v7
    v_perm_b32 v68, v98, v50, v4
    v_perm_b32 v69, v98, v50, v5
    v_perm_b32 v70, v98, v50, v6
    v_perm_b32 v71, v98, v50, v7
    v_perm_b32 v72, v99, v51, v4
    v_perm_b32 v73, v99, v51, v5
    v_perm_b32 v74, v99, v51, v6
    v_perm_b32 v75, v99, v51, v7
    s_waitcnt vmcnt(11)
    s_add_u32 s56, s56, 131072
    s_and_b32 s56, s56, 2097151
    s_add_u32 s68, s58, s56
    s_add_u32 s65, s65, 0x4000
    s_and_b32 s65, s65, 0x1ffff
    s_add_u32 s68, s68, s65
    buffer_load_dwordx4 v[104:107], v1, s[20:23], s68 offen offset:0 nt
    v_mfma_f32_16x16x32_bf16 v[12:15], v[60:63], a[0:3], v[12:15]
    s_waitcnt vmcnt(11)
    buffer_load_dwordx4 v[108:111], v1, s[20:23], s68 offen offset:64 nt
    v_mfma_f32_16x16x32_bf16 v[12:15], v[64:67], a[4:7], v[12:15]
    s_waitcnt vmcnt(11)
    buffer_load_dwordx4 v[112:115], v1, s[20:23], s68 offen offset:128 nt
    v_mfma_f32_16x16x32_bf16 v[12:15], v[68:71], a[8:11], v[12:15]
    s_waitcnt vmcnt(11)
    buffer_load_dwordx4 v[116:119], v1, s[20:23], s68 offen offset:192 nt
    v_mfma_f32_16x16x32_bf16 v[12:15], v[72:75], a[12:15], v[12:15]
    s_waitcnt vmcnt(11)
    buffer_load_dwordx4 a[0:3], v2, s[24:27], s68 offen offset:0 nt
    v_lshlrev_b32 v48, 16, v120
    v_and_b32 v49, s36, v120
    v_lshlrev_b32 v50, 16, v121
    v_and_b32 v51, s36, v121
    v_lshlrev_b32 v52, 16, v122
    v_and_b32 v53, s36, v122
    v_lshlrev_b32 v54, 16, v123
    v_and_b32 v55, s36, v123
    v_pk_mul_f32 v[48:49], v[48:49], s[34:35]
    v_pk_mul_f32 v[50:51], v[50:51], s[34:35]
    v_pk_mul_f32 v[52:53], v[52:53], s[34:35]
    v_pk_mul_f32 v[54:55], v[54:55], s[34:35]
    v_cvt_pk_bf16_f32 v120, v48, v49
    v_cvt_pk_bf16_f32 v121, v50, v51
    v_cvt_pk_bf16_f32 v122, v52, v53
    v_cvt_pk_bf16_f32 v123, v54, v55
    s_waitcnt vmcnt(11)
    buffer_load_dwordx4 a[4:7], v2, s[24:27], s68 offen offset:256 nt
    v_lshlrev_b32 v48, 16, v124
    v_and_b32 v49, s36, v124
    v_lshlrev_b32 v50, 16, v125
    v_and_b32 v51, s36, v125
    v_lshlrev_b32 v52, 16, v126
    v_and_b32 v53, s36, v126
    v_lshlrev_b32 v54, 16, v127
    v_and_b32 v55, s36, v127
    v_pk_mul_f32 v[48:49], v[48:49], s[34:35]
    v_pk_mul_f32 v[50:51], v[50:51], s[34:35]
    v_pk_mul_f32 v[52:53], v[52:53], s[34:35]
    v_pk_mul_f32 v[54:55], v[54:55], s[34:35]
    v_cvt_pk_bf16_f32 v124, v48, v49
    v_cvt_pk_bf16_f32 v125, v50, v51
    v_cvt_pk_bf16_f32 v126, v52, v53
    v_cvt_pk_bf16_f32 v127, v54, v55
    v_mfma_f32_16x16x32_bf16 v[40:43], v[120:123], v[120:123], 0
    v_mfma_f32_16x16x32_bf16 v[36:39], v[20:23], v[120:123], 0
    s_waitcnt vmcnt(11)
    buffer_load_dwordx4 a[8:11], v2, s[24:27], s68 offen offset:512 nt
    v_lshlrev_b32 v48, 16, v128
    v_and_b32 v49, s36, v128
    v_lshlrev_b32 v50, 16, v129
    v_and_b32 v51, s36, v129
    v_lshlrev_b32 v52, 16, v130
    v_and_b32 v53, s36, v130
    v_lshlrev_b32 v54, 16, v131
    v_and_b32 v55, s36, v131
    v_pk_mul_f32 v[48:49], v[48:49], s[34:35]
    v_pk_mul_f32 v[50:51], v[50:51], s[34:35]
    v_pk_mul_f32 v[52:53], v[52:53], s[34:35]
    v_pk_mul_f32 v[54:55], v[54:55], s[34:35]
    v_cvt_pk_bf16_f32 v128, v48, v49
    v_cvt_pk_bf16_f32 v129, v50, v51
    v_cvt_pk_bf16_f32 v130, v52, v53
    v_cvt_pk_bf16_f32 v131, v54, v55
    v_mfma_f32_16x16x32_bf16 v[40:43], v[124:127], v[124:127], v[40:43]
    v_mfma_f32_16x16x32_bf16 v[36:39], v[24:27], v[124:127], v[36:39]
    s_waitcnt vmcnt(11)
    buffer_load_dwordx4 a[12:15], v2, s[24:27], s68 offen offset:768 nt
    v_lshlrev_b32 v48, 16, v132
    v_and_b32 v49, s36, v132
    v_lshlrev_b32 v50, 16, v133
    v_and_b32 v51, s36, v133
    v_lshlrev_b32 v52, 16, v134
    v_and_b32 v53, s36, v134
    v_lshlrev_b32 v54, 16, v135
    v_and_b32 v55, s36, v135
    v_pk_mul_f32 v[48:49], v[48:49], s[34:35]
    v_pk_mul_f32 v[50:51], v[50:51], s[34:35]
    v_pk_mul_f32 v[52:53], v[52:53], s[34:35]
    v_pk_mul_f32 v[54:55], v[54:55], s[34:35]
    v_cvt_pk_bf16_f32 v132, v48, v49
    v_cvt_pk_bf16_f32 v133, v50, v51
    v_cvt_pk_bf16_f32 v134, v52, v53
    v_cvt_pk_bf16_f32 v135, v54, v55
    v_mfma_f32_16x16x32_bf16 v[40:43], v[128:131], v[128:131], v[40:43]
    v_mfma_f32_16x16x32_bf16 v[36:39], v[28:31], v[128:131], v[36:39]
    v_mfma_f32_16x16x32_bf16 v[40:43], v[132:135], v[132:135], v[40:43]
    v_mfma_f32_16x16x32_bf16 v[36:39], v[32:35], v[132:135], v[36:39]
    s_nop 6
    v_cndmask_b32 v10, 0, v40, s[48:49]
    v_cndmask_b32 v10, v10, v41, s[50:51]
    v_cndmask_b32 v10, v10, v42, s[52:53]
    v_cndmask_b32 v10, v10, v43, s[54:55]
    s_nop 1
    v_mfma_f32_16x16x4_f32 v[44:47], v3, v10, 0
    v_cvt_pk_bf16_f32 v36, 0, v36
    v_cvt_pk_bf16_f32 v37, 0, v37
    v_cvt_pk_bf16_f32 v38, 0, v38
    v_cvt_pk_bf16_f32 v39, 0, v39
    s_nop 5
    v_cvt_pk_bf16_f32 v11, 0, v44
    v_fma_f32 v36, v11, -0.5, v36
    v_fma_f32 v37, v11, -0.5, v37
    v_fma_f32 v38, v11, -0.5, v38
    v_fma_f32 v39, v11, -0.5, v39
    v_cvt_pk_bf16_f32 v36, 0, v36
    v_cvt_pk_bf16_f32 v37, 0, v37
    v_cvt_pk_bf16_f32 v38, 0, v38
    v_cvt_pk_bf16_f32 v39, 0, v39
    v_fma_f32 v36, v36, s37, -2.0
    v_fma_f32 v37, v37, s37, -2.0
    v_fma_f32 v38, v38, s37, -2.0
    v_fma_f32 v39, v39, s37, -2.0
    v_exp_f32 v36, v36
    v_exp_f32 v37, v37
    v_exp_f32 v38, v38
    v_exp_f32 v39, v39
    v_cvt_pk_bf16_f32 v36, 0, v36
    v_cvt_pk_bf16_f32 v37, 0, v37
    v_cvt_pk_bf16_f32 v38, 0, v38
    v_cvt_pk_bf16_f32 v39, 0, v39
    v_add_f32 v36, s38, v36
    v_add_f32 v37, s38, v37
    v_add_f32 v38, s38, v38
    v_add_f32 v39, s38, v39
    v_cvt_pk_bf16_f32 v56, v36, v37
    v_cvt_pk_bf16_f32 v57, v38, v39
    s_nop 1
    v_mfma_f32_16x16x16_bf16 v[100:103], v[56:57], v[8:9], 0
    v_mfma_f32_16x16x16_bf16 v[16:19], v[56:57], v[8:9], v[16:19]
    s_nop 6
    v_and_b32 v48, s36, v100
    v_and_b32 v49, s36, v101
    v_and_b32 v50, s36, v102
    v_and_b32 v51, s36, v103
    v_sub_f32 v48, v100, v48
    v_sub_f32 v49, v101, v49
    v_sub_f32 v50, v102, v50
    v_sub_f32 v51, v103, v51
    v_perm_b32 v60, v100, v48, v4
    v_perm_b32 v61, v100, v48, v5
    v_perm_b32 v62, v100, v48, v6
    v_perm_b32 v63, v100, v48, v7
    v_perm_b32 v64, v101, v49, v4
    v_perm_b32 v65, v101, v49, v5
    v_perm_b32 v66, v101, v49, v6
    v_perm_b32 v67, v101, v49, v7
    v_perm_b32 v68, v102, v50, v4
    v_perm_b32 v69, v102, v50, v5
    v_perm_b32 v70, v102, v50, v6
    v_perm_b32 v71, v102, v50, v7
    v_perm_b32 v72, v103, v51, v4
    v_perm_b32 v73, v103, v51, v5
    v_perm_b32 v74, v103, v51, v6
    v_perm_b32 v75, v103, v51, v7
    s_waitcnt vmcnt(11)
    s_add_u32 s56, s56, 131072
    s_and_b32 s56, s56, 2097151
    s_add_u32 s69, s58, s56
    s_add_u32 s65, s65, 0x4000
    s_and_b32 s65, s65, 0x1ffff
    s_add_u32 s69, s69, s65
    buffer_load_dwordx4 v[120:123], v1, s[20:23], s69 offen offset:0 nt
    v_mfma_f32_16x16x32_bf16 v[12:15], v[60:63], a[16:19], v[12:15]
    s_waitcnt vmcnt(11)
    buffer_load_dwordx4 v[124:127], v1, s[20:23], s69 offen offset:64 nt
    v_mfma_f32_16x16x32_bf16 v[12:15], v[64:67], a[20:23], v[12:15]
    s_waitcnt vmcnt(11)
    buffer_load_dwordx4 v[128:131], v1, s[20:23], s69 offen offset:128 nt
    v_mfma_f32_16x16x32_bf16 v[12:15], v[68:71], a[24:27], v[12:15]
    s_waitcnt vmcnt(11)
    buffer_load_dwordx4 v[132:135], v1, s[20:23], s69 offen offset:192 nt
    v_mfma_f32_16x16x32_bf16 v[12:15], v[72:75], a[28:31], v[12:15]
    s_waitcnt vmcnt(11)
    buffer_load_dwordx4 a[16:19], v2, s[24:27], s69 offen offset:0 nt
    v_lshlrev_b32 v48, 16, v104
    v_and_b32 v49, s36, v104
    v_lshlrev_b32 v50, 16, v105
    v_and_b32 v51, s36, v105
    v_lshlrev_b32 v52, 16, v106
    v_and_b32 v53, s36, v106
    v_lshlrev_b32 v54, 16, v107
    v_and_b32 v55, s36, v107
    v_pk_mul_f32 v[48:49], v[48:49], s[34:35]
    v_pk_mul_f32 v[50:51], v[50:51], s[34:35]
    v_pk_mul_f32 v[52:53], v[52:53], s[34:35]
    v_pk_mul_f32 v[54:55], v[54:55], s[34:35]
    v_cvt_pk_bf16_f32 v104, v48, v49
    v_cvt_pk_bf16_f32 v105, v50, v51
    v_cvt_pk_bf16_f32 v106, v52, v53
    v_cvt_pk_bf16_f32 v107, v54, v55
    s_waitcnt vmcnt(11)
    buffer_load_dwordx4 a[20:23], v2, s[24:27], s69 offen offset:256 nt
    v_lshlrev_b32 v48, 16, v108
    v_and_b32 v49, s36, v108
    v_lshlrev_b32 v50, 16, v109
    v_and_b32 v51, s36, v109
    v_lshlrev_b32 v52, 16, v110
    v_and_b32 v53, s36, v110
    v_lshlrev_b32 v54, 16, v111
    v_and_b32 v55, s36, v111
    v_pk_mul_f32 v[48:49], v[48:49], s[34:35]
    v_pk_mul_f32 v[50:51], v[50:51], s[34:35]
    v_pk_mul_f32 v[52:53], v[52:53], s[34:35]
    v_pk_mul_f32 v[54:55], v[54:55], s[34:35]
    v_cvt_pk_bf16_f32 v108, v48, v49
    v_cvt_pk_bf16_f32 v109, v50, v51
    v_cvt_pk_bf16_f32 v110, v52, v53
    v_cvt_pk_bf16_f32 v111, v54, v55
    v_mfma_f32_16x16x32_bf16 v[40:43], v[104:107], v[104:107], 0
    v_mfma_f32_16x16x32_bf16 v[36:39], v[20:23], v[104:107], 0
    s_waitcnt vmcnt(11)
    buffer_load_dwordx4 a[24:27], v2, s[24:27], s69 offen offset:512 nt
    v_lshlrev_b32 v48, 16, v112
    v_and_b32 v49, s36, v112
    v_lshlrev_b32 v50, 16, v113
    v_and_b32 v51, s36, v113
    v_lshlrev_b32 v52, 16, v114
    v_and_b32 v53, s36, v114
    v_lshlrev_b32 v54, 16, v115
    v_and_b32 v55, s36, v115
    v_pk_mul_f32 v[48:49], v[48:49], s[34:35]
    v_pk_mul_f32 v[50:51], v[50:51], s[34:35]
    v_pk_mul_f32 v[52:53], v[52:53], s[34:35]
    v_pk_mul_f32 v[54:55], v[54:55], s[34:35]
    v_cvt_pk_bf16_f32 v112, v48, v49
    v_cvt_pk_bf16_f32 v113, v50, v51
    v_cvt_pk_bf16_f32 v114, v52, v53
    v_cvt_pk_bf16_f32 v115, v54, v55
    v_mfma_f32_16x16x32_bf16 v[40:43], v[108:111], v[108:111], v[40:43]
    v_mfma_f32_16x16x32_bf16 v[36:39], v[24:27], v[108:111], v[36:39]
    s_waitcnt vmcnt(11)
    buffer_load_dwordx4 a[28:31], v2, s[24:27], s69 offen offset:768 nt
    v_lshlrev_b32 v48, 16, v116
    v_and_b32 v49, s36, v116
    v_lshlrev_b32 v50, 16, v117
    v_and_b32 v51, s36, v117
    v_lshlrev_b32 v52, 16, v118
    v_and_b32 v53, s36, v118
    v_lshlrev_b32 v54, 16, v119
    v_and_b32 v55, s36, v119
    v_pk_mul_f32 v[48:49], v[48:49], s[34:35]
    v_pk_mul_f32 v[50:51], v[50:51], s[34:35]
    v_pk_mul_f32 v[52:53], v[52:53], s[34:35]
    v_pk_mul_f32 v[54:55], v[54:55], s[34:35]
    v_cvt_pk_bf16_f32 v116, v48, v49
    v_cvt_pk_bf16_f32 v117, v50, v51
    v_cvt_pk_bf16_f32 v118, v52, v53
    v_cvt_pk_bf16_f32 v119, v54, v55
    v_mfma_f32_16x16x32_bf16 v[40:43], v[112:115], v[112:115], v[40:43]
    v_mfma_f32_16x16x32_bf16 v[36:39], v[28:31], v[112:115], v[36:39]
    v_mfma_f32_16x16x32_bf16 v[40:43], v[116:119], v[116:119], v[40:43]
    v_mfma_f32_16x16x32_bf16 v[36:39], v[32:35], v[116:119], v[36:39]
    s_nop 6
    v_cndmask_b32 v10, 0, v40, s[48:49]
    v_cndmask_b32 v10, v10, v41, s[50:51]
    v_cndmask_b32 v10, v10, v42, s[52:53]
    v_cndmask_b32 v10, v10, v43, s[54:55]
    s_nop 1
    v_mfma_f32_16x16x4_f32 v[44:47], v3, v10, 0
    v_cvt_pk_bf16_f32 v36, 0, v36
    v_cvt_pk_bf16_f32 v37, 0, v37
    v_cvt_pk_bf16_f32 v38, 0, v38
    v_cvt_pk_bf16_f32 v39, 0, v39
    s_nop 5
    v_cvt_pk_bf16_f32 v11, 0, v44
    v_fma_f32 v36, v11, -0.5, v36
    v_fma_f32 v37, v11, -0.5, v37
    v_fma_f32 v38, v11, -0.5, v38
    v_fma_f32 v39, v11, -0.5, v39
    v_cvt_pk_bf16_f32 v36, 0, v36
    v_cvt_pk_bf16_f32 v37, 0, v37
    v_cvt_pk_bf16_f32 v38, 0, v38
    v_cvt_pk_bf16_f32 v39, 0, v39
    v_fma_f32 v36, v36, s37, -2.0
    v_fma_f32 v37, v37, s37, -2.0
    v_fma_f32 v38, v38, s37, -2.0
    v_fma_f32 v39, v39, s37, -2.0
    v_exp_f32 v36, v36
    v_exp_f32 v37, v37
    v_exp_f32 v38, v38
    v_exp_f32 v39, v39
    v_cvt_pk_bf16_f32 v36, 0, v36
    v_cvt_pk_bf16_f32 v37, 0, v37
    v_cvt_pk_bf16_f32 v38, 0, v38
    v_cvt_pk_bf16_f32 v39, 0, v39
    v_add_f32 v36, s38, v36
    v_add_f32 v37, s38, v37
    v_add_f32 v38, s38, v38
    v_add_f32 v39, s38, v39
    v_cvt_pk_bf16_f32 v56, v36, v37
    v_cvt_pk_bf16_f32 v57, v38, v39
    s_nop 1
    v_mfma_f32_16x16x16_bf16 v[96:99], v[56:57], v[8:9], 0
    v_mfma_f32_16x16x16_bf16 v[16:19], v[56:57], v[8:9], v[16:19]
    s_nop 6
    v_and_b32 v48, s36, v96
    v_and_b32 v49, s36, v97
    v_and_b32 v50, s36, v98
    v_and_b32 v51, s36, v99
    v_sub_f32 v48, v96, v48
    v_sub_f32 v49, v97, v49
    v_sub_f32 v50, v98, v50
    v_sub_f32 v51, v99, v51
    v_perm_b32 v60, v96, v48, v4
    v_perm_b32 v61, v96, v48, v5
    v_perm_b32 v62, v96, v48, v6
    v_perm_b32 v63, v96, v48, v7
    v_perm_b32 v64, v97, v49, v4
    v_perm_b32 v65, v97, v49, v5
    v_perm_b32 v66, v97, v49, v6
    v_perm_b32 v67, v97, v49, v7
    v_perm_b32 v68, v98, v50, v4
    v_perm_b32 v69, v98, v50, v5
    v_perm_b32 v70, v98, v50, v6
    v_perm_b32 v71, v98, v50, v7
    v_perm_b32 v72, v99, v51, v4
    v_perm_b32 v73, v99, v51, v5
    v_perm_b32 v74, v99, v51, v6
    v_perm_b32 v75, v99, v51, v7
    s_waitcnt vmcnt(11)
    s_add_u32 s56, s56, 131072
    s_and_b32 s56, s56, 2097151
    s_add_u32 s68, s58, s56
    s_add_u32 s65, s65, 0x4000
    s_and_b32 s65, s65, 0x1ffff
    s_add_u32 s68, s68, s65
    buffer_load_dwordx4 v[104:107], v1, s[20:23], s68 offen offset:0 nt
    v_mfma_f32_16x16x32_bf16 v[12:15], v[60:63], a[0:3], v[12:15]
    s_waitcnt vmcnt(11)
    buffer_load_dwordx4 v[108:111], v1, s[20:23], s68 offen offset:64 nt
    v_mfma_f32_16x16x32_bf16 v[12:15], v[64:67], a[4:7], v[12:15]
    s_waitcnt vmcnt(11)
    buffer_load_dwordx4 v[112:115], v1, s[20:23], s68 offen offset:128 nt
    v_mfma_f32_16x16x32_bf16 v[12:15], v[68:71], a[8:11], v[12:15]
    s_waitcnt vmcnt(11)
    buffer_load_dwordx4 v[116:119], v1, s[20:23], s68 offen offset:192 nt
    v_mfma_f32_16x16x32_bf16 v[12:15], v[72:75], a[12:15], v[12:15]
    s_waitcnt vmcnt(11)
    buffer_load_dwordx4 a[0:3], v2, s[24:27], s68 offen offset:0 nt
    v_lshlrev_b32 v48, 16, v120
    v_and_b32 v49, s36, v120
    v_lshlrev_b32 v50, 16, v121
    v_and_b32 v51, s36, v121
    v_lshlrev_b32 v52, 16, v122
    v_and_b32 v53, s36, v122
    v_lshlrev_b32 v54, 16, v123
    v_and_b32 v55, s36, v123
    v_pk_mul_f32 v[48:49], v[48:49], s[34:35]
    v_pk_mul_f32 v[50:51], v[50:51], s[34:35]
    v_pk_mul_f32 v[52:53], v[52:53], s[34:35]
    v_pk_mul_f32 v[54:55], v[54:55], s[34:35]
    v_cvt_pk_bf16_f32 v120, v48, v49
    v_cvt_pk_bf16_f32 v121, v50, v51
    v_cvt_pk_bf16_f32 v122, v52, v53
    v_cvt_pk_bf16_f32 v123, v54, v55
    s_waitcnt vmcnt(11)
    buffer_load_dwordx4 a[4:7], v2, s[24:27], s68 offen offset:256 nt
    v_lshlrev_b32 v48, 16, v124
    v_and_b32 v49, s36, v124
    v_lshlrev_b32 v50, 16, v125
    v_and_b32 v51, s36, v125
    v_lshlrev_b32 v52, 16, v126
    v_and_b32 v53, s36, v126
    v_lshlrev_b32 v54, 16, v127
    v_and_b32 v55, s36, v127
    v_pk_mul_f32 v[48:49], v[48:49], s[34:35]
    v_pk_mul_f32 v[50:51], v[50:51], s[34:35]
    v_pk_mul_f32 v[52:53], v[52:53], s[34:35]
    v_pk_mul_f32 v[54:55], v[54:55], s[34:35]
    v_cvt_pk_bf16_f32 v124, v48, v49
    v_cvt_pk_bf16_f32 v125, v50, v51
    v_cvt_pk_bf16_f32 v126, v52, v53
    v_cvt_pk_bf16_f32 v127, v54, v55
    v_mfma_f32_16x16x32_bf16 v[40:43], v[120:123], v[120:123], 0
    v_mfma_f32_16x16x32_bf16 v[36:39], v[20:23], v[120:123], 0
    s_waitcnt vmcnt(11)
    buffer_load_dwordx4 a[8:11], v2, s[24:27], s68 offen offset:512 nt
    v_lshlrev_b32 v48, 16, v128
    v_and_b32 v49, s36, v128
    v_lshlrev_b32 v50, 16, v129
    v_and_b32 v51, s36, v129
    v_lshlrev_b32 v52, 16, v130
    v_and_b32 v53, s36, v130
    v_lshlrev_b32 v54, 16, v131
    v_and_b32 v55, s36, v131
    v_pk_mul_f32 v[48:49], v[48:49], s[34:35]
    v_pk_mul_f32 v[50:51], v[50:51], s[34:35]
    v_pk_mul_f32 v[52:53], v[52:53], s[34:35]
    v_pk_mul_f32 v[54:55], v[54:55], s[34:35]
    v_cvt_pk_bf16_f32 v128, v48, v49
    v_cvt_pk_bf16_f32 v129, v50, v51
    v_cvt_pk_bf16_f32 v130, v52, v53
    v_cvt_pk_bf16_f32 v131, v54, v55
    v_mfma_f32_16x16x32_bf16 v[40:43], v[124:127], v[124:127], v[40:43]
    v_mfma_f32_16x16x32_bf16 v[36:39], v[24:27], v[124:127], v[36:39]
    s_waitcnt vmcnt(11)
    buffer_load_dwordx4 a[12:15], v2, s[24:27], s68 offen offset:768 nt
    v_lshlrev_b32 v48, 16, v132
    v_and_b32 v49, s36, v132
    v_lshlrev_b32 v50, 16, v133
    v_and_b32 v51, s36, v133
    v_lshlrev_b32 v52, 16, v134
    v_and_b32 v53, s36, v134
    v_lshlrev_b32 v54, 16, v135
    v_and_b32 v55, s36, v135
    v_pk_mul_f32 v[48:49], v[48:49], s[34:35]
    v_pk_mul_f32 v[50:51], v[50:51], s[34:35]
    v_pk_mul_f32 v[52:53], v[52:53], s[34:35]
    v_pk_mul_f32 v[54:55], v[54:55], s[34:35]
    v_cvt_pk_bf16_f32 v132, v48, v49
    v_cvt_pk_bf16_f32 v133, v50, v51
    v_cvt_pk_bf16_f32 v134, v52, v53
    v_cvt_pk_bf16_f32 v135, v54, v55
    v_mfma_f32_16x16x32_bf16 v[40:43], v[128:131], v[128:131], v[40:43]
    v_mfma_f32_16x16x32_bf16 v[36:39], v[28:31], v[128:131], v[36:39]
    v_mfma_f32_16x16x32_bf16 v[40:43], v[132:135], v[132:135], v[40:43]
    v_mfma_f32_16x16x32_bf16 v[36:39], v[32:35], v[132:135], v[36:39]
    s_nop 6
    v_cndmask_b32 v10, 0, v40, s[48:49]
    v_cndmask_b32 v10, v10, v41, s[50:51]
    v_cndmask_b32 v10, v10, v42, s[52:53]
    v_cndmask_b32 v10, v10, v43, s[54:55]
    s_nop 1
    v_mfma_f32_16x16x4_f32 v[44:47], v3, v10, 0
    v_cvt_pk_bf16_f32 v36, 0, v36
    v_cvt_pk_bf16_f32 v37, 0, v37
    v_cvt_pk_bf16_f32 v38, 0, v38
    v_cvt_pk_bf16_f32 v39, 0, v39
    s_nop 5
    v_cvt_pk_bf16_f32 v11, 0, v44
    v_fma_f32 v36, v11, -0.5, v36
    v_fma_f32 v37, v11, -0.5, v37
    v_fma_f32 v38, v11, -0.5, v38
    v_fma_f32 v39, v11, -0.5, v39
    v_cvt_pk_bf16_f32 v36, 0, v36
    v_cvt_pk_bf16_f32 v37, 0, v37
    v_cvt_pk_bf16_f32 v38, 0, v38
    v_cvt_pk_bf16_f32 v39, 0, v39
    v_fma_f32 v36, v36, s37, -2.0
    v_fma_f32 v37, v37, s37, -2.0
    v_fma_f32 v38, v38, s37, -2.0
    v_fma_f32 v39, v39, s37, -2.0
    v_exp_f32 v36, v36
    v_exp_f32 v37, v37
    v_exp_f32 v38, v38
    v_exp_f32 v39, v39
    v_cvt_pk_bf16_f32 v36, 0, v36
    v_cvt_pk_bf16_f32 v37, 0, v37
    v_cvt_pk_bf16_f32 v38, 0, v38
    v_cvt_pk_bf16_f32 v39, 0, v39
    v_add_f32 v36, s38, v36
    v_add_f32 v37, s38, v37
    v_add_f32 v38, s38, v38
    v_add_f32 v39, s38, v39
    v_cvt_pk_bf16_f32 v56, v36, v37
    v_cvt_pk_bf16_f32 v57, v38, v39
    s_nop 1
    v_mfma_f32_16x16x16_bf16 v[100:103], v[56:57], v[8:9], 0
    v_mfma_f32_16x16x16_bf16 v[16:19], v[56:57], v[8:9], v[16:19]
    s_nop 6
    v_and_b32 v48, s36, v100
    v_and_b32 v49, s36, v101
    v_and_b32 v50, s36, v102
    v_and_b32 v51, s36, v103
    v_sub_f32 v48, v100, v48
    v_sub_f32 v49, v101, v49
    v_sub_f32 v50, v102, v50
    v_sub_f32 v51, v103, v51
    v_perm_b32 v60, v100, v48, v4
    v_perm_b32 v61, v100, v48, v5
    v_perm_b32 v62, v100, v48, v6
    v_perm_b32 v63, v100, v48, v7
    v_perm_b32 v64, v101, v49, v4
    v_perm_b32 v65, v101, v49, v5
    v_perm_b32 v66, v101, v49, v6
    v_perm_b32 v67, v101, v49, v7
    v_perm_b32 v68, v102, v50, v4
    v_perm_b32 v69, v102, v50, v5
    v_perm_b32 v70, v102, v50, v6
    v_perm_b32 v71, v102, v50, v7
    v_perm_b32 v72, v103, v51, v4
    v_perm_b32 v73, v103, v51, v5
    v_perm_b32 v74, v103, v51, v6
    v_perm_b32 v75, v103, v51, v7
    s_waitcnt vmcnt(11)
    s_add_u32 s56, s56, 131072
    s_and_b32 s56, s56, 2097151
    s_add_u32 s69, s58, s56
    s_add_u32 s65, s65, 0x4000
    s_and_b32 s65, s65, 0x1ffff
    s_add_u32 s69, s69, s65
    buffer_load_dwordx4 v[120:123], v1, s[20:23], s69 offen offset:0 nt
    v_mfma_f32_16x16x32_bf16 v[12:15], v[60:63], a[16:19], v[12:15]
    s_waitcnt vmcnt(11)
    buffer_load_dwordx4 v[124:127], v1, s[20:23], s69 offen offset:64 nt
    v_mfma_f32_16x16x32_bf16 v[12:15], v[64:67], a[20:23], v[12:15]
    s_waitcnt vmcnt(11)
    buffer_load_dwordx4 v[128:131], v1, s[20:23], s69 offen offset:128 nt
    v_mfma_f32_16x16x32_bf16 v[12:15], v[68:71], a[24:27], v[12:15]
    s_waitcnt vmcnt(11)
    buffer_load_dwordx4 v[132:135], v1, s[20:23], s69 offen offset:192 nt
    v_mfma_f32_16x16x32_bf16 v[12:15], v[72:75], a[28:31], v[12:15]
    s_waitcnt vmcnt(11)
    buffer_load_dwordx4 a[16:19], v2, s[24:27], s69 offen offset:0 nt
    v_lshlrev_b32 v48, 16, v104
    v_and_b32 v49, s36, v104
    v_lshlrev_b32 v50, 16, v105
    v_and_b32 v51, s36, v105
    v_lshlrev_b32 v52, 16, v106
    v_and_b32 v53, s36, v106
    v_lshlrev_b32 v54, 16, v107
    v_and_b32 v55, s36, v107
    v_pk_mul_f32 v[48:49], v[48:49], s[34:35]
    v_pk_mul_f32 v[50:51], v[50:51], s[34:35]
    v_pk_mul_f32 v[52:53], v[52:53], s[34:35]
    v_pk_mul_f32 v[54:55], v[54:55], s[34:35]
    v_cvt_pk_bf16_f32 v104, v48, v49
    v_cvt_pk_bf16_f32 v105, v50, v51
    v_cvt_pk_bf16_f32 v106, v52, v53
    v_cvt_pk_bf16_f32 v107, v54, v55
    s_waitcnt vmcnt(11)
    buffer_load_dwordx4 a[20:23], v2, s[24:27], s69 offen offset:256 nt
    v_lshlrev_b32 v48, 16, v108
    v_and_b32 v49, s36, v108
    v_lshlrev_b32 v50, 16, v109
    v_and_b32 v51, s36, v109
    v_lshlrev_b32 v52, 16, v110
    v_and_b32 v53, s36, v110
    v_lshlrev_b32 v54, 16, v111
    v_and_b32 v55, s36, v111
    v_pk_mul_f32 v[48:49], v[48:49], s[34:35]
    v_pk_mul_f32 v[50:51], v[50:51], s[34:35]
    v_pk_mul_f32 v[52:53], v[52:53], s[34:35]
    v_pk_mul_f32 v[54:55], v[54:55], s[34:35]
    v_cvt_pk_bf16_f32 v108, v48, v49
    v_cvt_pk_bf16_f32 v109, v50, v51
    v_cvt_pk_bf16_f32 v110, v52, v53
    v_cvt_pk_bf16_f32 v111, v54, v55
    v_mfma_f32_16x16x32_bf16 v[40:43], v[104:107], v[104:107], 0
    v_mfma_f32_16x16x32_bf16 v[36:39], v[20:23], v[104:107], 0
    s_waitcnt vmcnt(11)
    buffer_load_dwordx4 a[24:27], v2, s[24:27], s69 offen offset:512 nt
    v_lshlrev_b32 v48, 16, v112
    v_and_b32 v49, s36, v112
    v_lshlrev_b32 v50, 16, v113
    v_and_b32 v51, s36, v113
    v_lshlrev_b32 v52, 16, v114
    v_and_b32 v53, s36, v114
    v_lshlrev_b32 v54, 16, v115
    v_and_b32 v55, s36, v115
    v_pk_mul_f32 v[48:49], v[48:49], s[34:35]
    v_pk_mul_f32 v[50:51], v[50:51], s[34:35]
    v_pk_mul_f32 v[52:53], v[52:53], s[34:35]
    v_pk_mul_f32 v[54:55], v[54:55], s[34:35]
    v_cvt_pk_bf16_f32 v112, v48, v49
    v_cvt_pk_bf16_f32 v113, v50, v51
    v_cvt_pk_bf16_f32 v114, v52, v53
    v_cvt_pk_bf16_f32 v115, v54, v55
    v_mfma_f32_16x16x32_bf16 v[40:43], v[108:111], v[108:111], v[40:43]
    v_mfma_f32_16x16x32_bf16 v[36:39], v[24:27], v[108:111], v[36:39]
    s_waitcnt vmcnt(11)
    buffer_load_dwordx4 a[28:31], v2, s[24:27], s69 offen offset:768 nt
    v_lshlrev_b32 v48, 16, v116
    v_and_b32 v49, s36, v116
    v_lshlrev_b32 v50, 16, v117
    v_and_b32 v51, s36, v117
    v_lshlrev_b32 v52, 16, v118
    v_and_b32 v53, s36, v118
    v_lshlrev_b32 v54, 16, v119
    v_and_b32 v55, s36, v119
    v_pk_mul_f32 v[48:49], v[48:49], s[34:35]
    v_pk_mul_f32 v[50:51], v[50:51], s[34:35]
    v_pk_mul_f32 v[52:53], v[52:53], s[34:35]
    v_pk_mul_f32 v[54:55], v[54:55], s[34:35]
    v_cvt_pk_bf16_f32 v116, v48, v49
    v_cvt_pk_bf16_f32 v117, v50, v51
    v_cvt_pk_bf16_f32 v118, v52, v53
    v_cvt_pk_bf16_f32 v119, v54, v55
    v_mfma_f32_16x16x32_bf16 v[40:43], v[112:115], v[112:115], v[40:43]
    v_mfma_f32_16x16x32_bf16 v[36:39], v[28:31], v[112:115], v[36:39]
    v_mfma_f32_16x16x32_bf16 v[40:43], v[116:119], v[116:119], v[40:43]
    v_mfma_f32_16x16x32_bf16 v[36:39], v[32:35], v[116:119], v[36:39]
    s_nop 6
    v_cndmask_b32 v10, 0, v40, s[48:49]
    v_cndmask_b32 v10, v10, v41, s[50:51]
    v_cndmask_b32 v10, v10, v42, s[52:53]
    v_cndmask_b32 v10, v10, v43, s[54:55]
    s_nop 1
    v_mfma_f32_16x16x4_f32 v[44:47], v3, v10, 0
    v_cvt_pk_bf16_f32 v36, 0, v36
    v_cvt_pk_bf16_f32 v37, 0, v37
    v_cvt_pk_bf16_f32 v38, 0, v38
    v_cvt_pk_bf16_f32 v39, 0, v39
    s_nop 5
    v_cvt_pk_bf16_f32 v11, 0, v44
    v_fma_f32 v36, v11, -0.5, v36
    v_fma_f32 v37, v11, -0.5, v37
    v_fma_f32 v38, v11, -0.5, v38
    v_fma_f32 v39, v11, -0.5, v39
    v_cvt_pk_bf16_f32 v36, 0, v36
    v_cvt_pk_bf16_f32 v37, 0, v37
    v_cvt_pk_bf16_f32 v38, 0, v38
    v_cvt_pk_bf16_f32 v39, 0, v39
    v_fma_f32 v36, v36, s37, -2.0
    v_fma_f32 v37, v37, s37, -2.0
    v_fma_f32 v38, v38, s37, -2.0
    v_fma_f32 v39, v39, s37, -2.0
    v_exp_f32 v36, v36
    v_exp_f32 v37, v37
    v_exp_f32 v38, v38
    v_exp_f32 v39, v39
    v_cvt_pk_bf16_f32 v36, 0, v36
    v_cvt_pk_bf16_f32 v37, 0, v37
    v_cvt_pk_bf16_f32 v38, 0, v38
    v_cvt_pk_bf16_f32 v39, 0, v39
    v_add_f32 v36, s38, v36
    v_add_f32 v37, s38, v37
    v_add_f32 v38, s38, v38
    v_add_f32 v39, s38, v39
    v_cvt_pk_bf16_f32 v56, v36, v37
    v_cvt_pk_bf16_f32 v57, v38, v39
    s_nop 1
    v_mfma_f32_16x16x16_bf16 v[96:99], v[56:57], v[8:9], 0
    v_mfma_f32_16x16x16_bf16 v[16:19], v[56:57], v[8:9], v[16:19]
    s_nop 6
    v_and_b32 v48, s36, v96
    v_and_b32 v49, s36, v97
    v_and_b32 v50, s36, v98
    v_and_b32 v51, s36, v99
    v_sub_f32 v48, v96, v48
    v_sub_f32 v49, v97, v49
    v_sub_f32 v50, v98, v50
    v_sub_f32 v51, v99, v51
    v_perm_b32 v60, v96, v48, v4
    v_perm_b32 v61, v96, v48, v5
    v_perm_b32 v62, v96, v48, v6
    v_perm_b32 v63, v96, v48, v7
    v_perm_b32 v64, v97, v49, v4
    v_perm_b32 v65, v97, v49, v5
    v_perm_b32 v66, v97, v49, v6
    v_perm_b32 v67, v97, v49, v7
    v_perm_b32 v68, v98, v50, v4
    v_perm_b32 v69, v98, v50, v5
    v_perm_b32 v70, v98, v50, v6
    v_perm_b32 v71, v98, v50, v7
    v_perm_b32 v72, v99, v51, v4
    v_perm_b32 v73, v99, v51, v5
    v_perm_b32 v74, v99, v51, v6
    v_perm_b32 v75, v99, v51, v7
    s_waitcnt vmcnt(11)
    s_add_u32 s56, s56, 131072
    s_and_b32 s56, s56, 2097151
    s_add_u32 s68, s58, s56
    s_add_u32 s65, s65, 0x4000
    s_and_b32 s65, s65, 0x1ffff
    s_add_u32 s68, s68, s65
    buffer_load_dwordx4 v[104:107], v1, s[20:23], s68 offen offset:0 nt
    v_mfma_f32_16x16x32_bf16 v[12:15], v[60:63], a[0:3], v[12:15]
    s_waitcnt vmcnt(11)
    buffer_load_dwordx4 v[108:111], v1, s[20:23], s68 offen offset:64 nt
    v_mfma_f32_16x16x32_bf16 v[12:15], v[64:67], a[4:7], v[12:15]
    s_waitcnt vmcnt(11)
    buffer_load_dwordx4 v[112:115], v1, s[20:23], s68 offen offset:128 nt
    v_mfma_f32_16x16x32_bf16 v[12:15], v[68:71], a[8:11], v[12:15]
    s_waitcnt vmcnt(11)
    buffer_load_dwordx4 v[116:119], v1, s[20:23], s68 offen offset:192 nt
    v_mfma_f32_16x16x32_bf16 v[12:15], v[72:75], a[12:15], v[12:15]
    s_waitcnt vmcnt(11)
    buffer_load_dwordx4 a[0:3], v2, s[24:27], s68 offen offset:0 nt
    v_lshlrev_b32 v48, 16, v120
    v_and_b32 v49, s36, v120
    v_lshlrev_b32 v50, 16, v121
    v_and_b32 v51, s36, v121
    v_lshlrev_b32 v52, 16, v122
    v_and_b32 v53, s36, v122
    v_lshlrev_b32 v54, 16, v123
    v_and_b32 v55, s36, v123
    v_pk_mul_f32 v[48:49], v[48:49], s[34:35]
    v_pk_mul_f32 v[50:51], v[50:51], s[34:35]
    v_pk_mul_f32 v[52:53], v[52:53], s[34:35]
    v_pk_mul_f32 v[54:55], v[54:55], s[34:35]
    v_cvt_pk_bf16_f32 v120, v48, v49
    v_cvt_pk_bf16_f32 v121, v50, v51
    v_cvt_pk_bf16_f32 v122, v52, v53
    v_cvt_pk_bf16_f32 v123, v54, v55
    s_waitcnt vmcnt(11)
    buffer_load_dwordx4 a[4:7], v2, s[24:27], s68 offen offset:256 nt
    v_lshlrev_b32 v48, 16, v124
    v_and_b32 v49, s36, v124
    v_lshlrev_b32 v50, 16, v125
    v_and_b32 v51, s36, v125
    v_lshlrev_b32 v52, 16, v126
    v_and_b32 v53, s36, v126
    v_lshlrev_b32 v54, 16, v127
    v_and_b32 v55, s36, v127
    v_pk_mul_f32 v[48:49], v[48:49], s[34:35]
    v_pk_mul_f32 v[50:51], v[50:51], s[34:35]
    v_pk_mul_f32 v[52:53], v[52:53], s[34:35]
    v_pk_mul_f32 v[54:55], v[54:55], s[34:35]
    v_cvt_pk_bf16_f32 v124, v48, v49
    v_cvt_pk_bf16_f32 v125, v50, v51
    v_cvt_pk_bf16_f32 v126, v52, v53
    v_cvt_pk_bf16_f32 v127, v54, v55
    v_mfma_f32_16x16x32_bf16 v[40:43], v[120:123], v[120:123], 0
    v_mfma_f32_16x16x32_bf16 v[36:39], v[20:23], v[120:123], 0
    s_waitcnt vmcnt(11)
    buffer_load_dwordx4 a[8:11], v2, s[24:27], s68 offen offset:512 nt
    v_lshlrev_b32 v48, 16, v128
    v_and_b32 v49, s36, v128
    v_lshlrev_b32 v50, 16, v129
    v_and_b32 v51, s36, v129
    v_lshlrev_b32 v52, 16, v130
    v_and_b32 v53, s36, v130
    v_lshlrev_b32 v54, 16, v131
    v_and_b32 v55, s36, v131
    v_pk_mul_f32 v[48:49], v[48:49], s[34:35]
    v_pk_mul_f32 v[50:51], v[50:51], s[34:35]
    v_pk_mul_f32 v[52:53], v[52:53], s[34:35]
    v_pk_mul_f32 v[54:55], v[54:55], s[34:35]
    v_cvt_pk_bf16_f32 v128, v48, v49
    v_cvt_pk_bf16_f32 v129, v50, v51
    v_cvt_pk_bf16_f32 v130, v52, v53
    v_cvt_pk_bf16_f32 v131, v54, v55
    v_mfma_f32_16x16x32_bf16 v[40:43], v[124:127], v[124:127], v[40:43]
    v_mfma_f32_16x16x32_bf16 v[36:39], v[24:27], v[124:127], v[36:39]
    s_waitcnt vmcnt(11)
    buffer_load_dwordx4 a[12:15], v2, s[24:27], s68 offen offset:768 nt
    v_lshlrev_b32 v48, 16, v132
    v_and_b32 v49, s36, v132
    v_lshlrev_b32 v50, 16, v133
    v_and_b32 v51, s36, v133
    v_lshlrev_b32 v52, 16, v134
    v_and_b32 v53, s36, v134
    v_lshlrev_b32 v54, 16, v135
    v_and_b32 v55, s36, v135
    v_pk_mul_f32 v[48:49], v[48:49], s[34:35]
    v_pk_mul_f32 v[50:51], v[50:51], s[34:35]
    v_pk_mul_f32 v[52:53], v[52:53], s[34:35]
    v_pk_mul_f32 v[54:55], v[54:55], s[34:35]
    v_cvt_pk_bf16_f32 v132, v48, v49
    v_cvt_pk_bf16_f32 v133, v50, v51
    v_cvt_pk_bf16_f32 v134, v52, v53
    v_cvt_pk_bf16_f32 v135, v54, v55
    v_mfma_f32_16x16x32_bf16 v[40:43], v[128:131], v[128:131], v[40:43]
    v_mfma_f32_16x16x32_bf16 v[36:39], v[28:31], v[128:131], v[36:39]
    v_mfma_f32_16x16x32_bf16 v[40:43], v[132:135], v[132:135], v[40:43]
    v_mfma_f32_16x16x32_bf16 v[36:39], v[32:35], v[132:135], v[36:39]
    s_nop 6
    v_cndmask_b32 v10, 0, v40, s[48:49]
    v_cndmask_b32 v10, v10, v41, s[50:51]
    v_cndmask_b32 v10, v10, v42, s[52:53]
    v_cndmask_b32 v10, v10, v43, s[54:55]
    s_nop 1
    v_mfma_f32_16x16x4_f32 v[44:47], v3, v10, 0
    v_cvt_pk_bf16_f32 v36, 0, v36
    v_cvt_pk_bf16_f32 v37, 0, v37
    v_cvt_pk_bf16_f32 v38, 0, v38
    v_cvt_pk_bf16_f32 v39, 0, v39
    s_nop 5
    v_cvt_pk_bf16_f32 v11, 0, v44
    v_fma_f32 v36, v11, -0.5, v36
    v_fma_f32 v37, v11, -0.5, v37
    v_fma_f32 v38, v11, -0.5, v38
    v_fma_f32 v39, v11, -0.5, v39
    v_cvt_pk_bf16_f32 v36, 0, v36
    v_cvt_pk_bf16_f32 v37, 0, v37
    v_cvt_pk_bf16_f32 v38, 0, v38
    v_cvt_pk_bf16_f32 v39, 0, v39
    v_fma_f32 v36, v36, s37, -2.0
    v_fma_f32 v37, v37, s37, -2.0
    v_fma_f32 v38, v38, s37, -2.0
    v_fma_f32 v39, v39, s37, -2.0
    v_exp_f32 v36, v36
    v_exp_f32 v37, v37
    v_exp_f32 v38, v38
    v_exp_f32 v39, v39
    v_cvt_pk_bf16_f32 v36, 0, v36
    v_cvt_pk_bf16_f32 v37, 0, v37
    v_cvt_pk_bf16_f32 v38, 0, v38
    v_cvt_pk_bf16_f32 v39, 0, v39
    v_add_f32 v36, s38, v36
    v_add_f32 v37, s38, v37
    v_add_f32 v38, s38, v38
    v_add_f32 v39, s38, v39
    v_cvt_pk_bf16_f32 v56, v36, v37
    v_cvt_pk_bf16_f32 v57, v38, v39
    s_nop 1
    v_mfma_f32_16x16x16_bf16 v[100:103], v[56:57], v[8:9], 0
    v_mfma_f32_16x16x16_bf16 v[16:19], v[56:57], v[8:9], v[16:19]
    s_nop 6
    v_and_b32 v48, s36, v100
    v_and_b32 v49, s36, v101
    v_and_b32 v50, s36, v102
    v_and_b32 v51, s36, v103
    v_sub_f32 v48, v100, v48
    v_sub_f32 v49, v101, v49
    v_sub_f32 v50, v102, v50
    v_sub_f32 v51, v103, v51
    v_perm_b32 v60, v100, v48, v4
    v_perm_b32 v61, v100, v48, v5
    v_perm_b32 v62, v100, v48, v6
    v_perm_b32 v63, v100, v48, v7
    v_perm_b32 v64, v101, v49, v4
    v_perm_b32 v65, v101, v49, v5
    v_perm_b32 v66, v101, v49, v6
    v_perm_b32 v67, v101, v49, v7
    v_perm_b32 v68, v102, v50, v4
    v_perm_b32 v69, v102, v50, v5
    v_perm_b32 v70, v102, v50, v6
    v_perm_b32 v71, v102, v50, v7
    v_perm_b32 v72, v103, v51, v4
    v_perm_b32 v73, v103, v51, v5
    v_perm_b32 v74, v103, v51, v6
    v_perm_b32 v75, v103, v51, v7
    s_waitcnt vmcnt(11)
    s_add_u32 s56, s56, 131072
    s_and_b32 s56, s56, 2097151
    s_add_u32 s69, s58, s56
    s_add_u32 s65, s65, 0x4000
    s_and_b32 s65, s65, 0x1ffff
    s_add_u32 s69, s69, s65
    buffer_load_dwordx4 v[120:123], v1, s[20:23], s69 offen offset:0 nt
    v_mfma_f32_16x16x32_bf16 v[12:15], v[60:63], a[16:19], v[12:15]
    s_waitcnt vmcnt(11)
    buffer_load_dwordx4 v[124:127], v1, s[20:23], s69 offen offset:64 nt
    v_mfma_f32_16x16x32_bf16 v[12:15], v[64:67], a[20:23], v[12:15]
    s_waitcnt vmcnt(11)
    buffer_load_dwordx4 v[128:131], v1, s[20:23], s69 offen offset:128 nt
    v_mfma_f32_16x16x32_bf16 v[12:15], v[68:71], a[24:27], v[12:15]
    s_waitcnt vmcnt(11)
    buffer_load_dwordx4 v[132:135], v1, s[20:23], s69 offen offset:192 nt
    v_mfma_f32_16x16x32_bf16 v[12:15], v[72:75], a[28:31], v[12:15]
    s_waitcnt vmcnt(11)
    buffer_load_dwordx4 a[16:19], v2, s[24:27], s69 offen offset:0 nt
    v_lshlrev_b32 v48, 16, v104
    v_and_b32 v49, s36, v104
    v_lshlrev_b32 v50, 16, v105
    v_and_b32 v51, s36, v105
    v_lshlrev_b32 v52, 16, v106
    v_and_b32 v53, s36, v106
    v_lshlrev_b32 v54, 16, v107
    v_and_b32 v55, s36, v107
    v_pk_mul_f32 v[48:49], v[48:49], s[34:35]
    v_pk_mul_f32 v[50:51], v[50:51], s[34:35]
    v_pk_mul_f32 v[52:53], v[52:53], s[34:35]
    v_pk_mul_f32 v[54:55], v[54:55], s[34:35]
    v_cvt_pk_bf16_f32 v104, v48, v49
    v_cvt_pk_bf16_f32 v105, v50, v51
    v_cvt_pk_bf16_f32 v106, v52, v53
    v_cvt_pk_bf16_f32 v107, v54, v55
    s_waitcnt vmcnt(11)
    buffer_load_dwordx4 a[20:23], v2, s[24:27], s69 offen offset:256 nt
    v_lshlrev_b32 v48, 16, v108
    v_and_b32 v49, s36, v108
    v_lshlrev_b32 v50, 16, v109
    v_and_b32 v51, s36, v109
    v_lshlrev_b32 v52, 16, v110
    v_and_b32 v53, s36, v110
    v_lshlrev_b32 v54, 16, v111
    v_and_b32 v55, s36, v111
    v_pk_mul_f32 v[48:49], v[48:49], s[34:35]
    v_pk_mul_f32 v[50:51], v[50:51], s[34:35]
    v_pk_mul_f32 v[52:53], v[52:53], s[34:35]
    v_pk_mul_f32 v[54:55], v[54:55], s[34:35]
    v_cvt_pk_bf16_f32 v108, v48, v49
    v_cvt_pk_bf16_f32 v109, v50, v51
    v_cvt_pk_bf16_f32 v110, v52, v53
    v_cvt_pk_bf16_f32 v111, v54, v55
    v_mfma_f32_16x16x32_bf16 v[40:43], v[104:107], v[104:107], 0
    v_mfma_f32_16x16x32_bf16 v[36:39], v[20:23], v[104:107], 0
    s_waitcnt vmcnt(11)
    buffer_load_dwordx4 a[24:27], v2, s[24:27], s69 offen offset:512 nt
    v_lshlrev_b32 v48, 16, v112
    v_and_b32 v49, s36, v112
    v_lshlrev_b32 v50, 16, v113
    v_and_b32 v51, s36, v113
    v_lshlrev_b32 v52, 16, v114
    v_and_b32 v53, s36, v114
    v_lshlrev_b32 v54, 16, v115
    v_and_b32 v55, s36, v115
    v_pk_mul_f32 v[48:49], v[48:49], s[34:35]
    v_pk_mul_f32 v[50:51], v[50:51], s[34:35]
    v_pk_mul_f32 v[52:53], v[52:53], s[34:35]
    v_pk_mul_f32 v[54:55], v[54:55], s[34:35]
    v_cvt_pk_bf16_f32 v112, v48, v49
    v_cvt_pk_bf16_f32 v113, v50, v51
    v_cvt_pk_bf16_f32 v114, v52, v53
    v_cvt_pk_bf16_f32 v115, v54, v55
    v_mfma_f32_16x16x32_bf16 v[40:43], v[108:111], v[108:111], v[40:43]
    v_mfma_f32_16x16x32_bf16 v[36:39], v[24:27], v[108:111], v[36:39]
    s_waitcnt vmcnt(11)
    buffer_load_dwordx4 a[28:31], v2, s[24:27], s69 offen offset:768 nt
    v_lshlrev_b32 v48, 16, v116
    v_and_b32 v49, s36, v116
    v_lshlrev_b32 v50, 16, v117
    v_and_b32 v51, s36, v117
    v_lshlrev_b32 v52, 16, v118
    v_and_b32 v53, s36, v118
    v_lshlrev_b32 v54, 16, v119
    v_and_b32 v55, s36, v119
    v_pk_mul_f32 v[48:49], v[48:49], s[34:35]
    v_pk_mul_f32 v[50:51], v[50:51], s[34:35]
    v_pk_mul_f32 v[52:53], v[52:53], s[34:35]
    v_pk_mul_f32 v[54:55], v[54:55], s[34:35]
    v_cvt_pk_bf16_f32 v116, v48, v49
    v_cvt_pk_bf16_f32 v117, v50, v51
    v_cvt_pk_bf16_f32 v118, v52, v53
    v_cvt_pk_bf16_f32 v119, v54, v55
    v_mfma_f32_16x16x32_bf16 v[40:43], v[112:115], v[112:115], v[40:43]
    v_mfma_f32_16x16x32_bf16 v[36:39], v[28:31], v[112:115], v[36:39]
    v_mfma_f32_16x16x32_bf16 v[40:43], v[116:119], v[116:119], v[40:43]
    v_mfma_f32_16x16x32_bf16 v[36:39], v[32:35], v[116:119], v[36:39]
    s_nop 6
    v_cndmask_b32 v10, 0, v40, s[48:49]
    v_cndmask_b32 v10, v10, v41, s[50:51]
    v_cndmask_b32 v10, v10, v42, s[52:53]
    v_cndmask_b32 v10, v10, v43, s[54:55]
    s_nop 1
    v_mfma_f32_16x16x4_f32 v[44:47], v3, v10, 0
    v_cvt_pk_bf16_f32 v36, 0, v36
    v_cvt_pk_bf16_f32 v37, 0, v37
    v_cvt_pk_bf16_f32 v38, 0, v38
    v_cvt_pk_bf16_f32 v39, 0, v39
    s_nop 5
    v_cvt_pk_bf16_f32 v11, 0, v44
    v_fma_f32 v36, v11, -0.5, v36
    v_fma_f32 v37, v11, -0.5, v37
    v_fma_f32 v38, v11, -0.5, v38
    v_fma_f32 v39, v11, -0.5, v39
    v_cvt_pk_bf16_f32 v36, 0, v36
    v_cvt_pk_bf16_f32 v37, 0, v37
    v_cvt_pk_bf16_f32 v38, 0, v38
    v_cvt_pk_bf16_f32 v39, 0, v39
    v_fma_f32 v36, v36, s37, -2.0
    v_fma_f32 v37, v37, s37, -2.0
    v_fma_f32 v38, v38, s37, -2.0
    v_fma_f32 v39, v39, s37, -2.0
    v_exp_f32 v36, v36
    v_exp_f32 v37, v37
    v_exp_f32 v38, v38
    v_exp_f32 v39, v39
    v_cvt_pk_bf16_f32 v36, 0, v36
    v_cvt_pk_bf16_f32 v37, 0, v37
    v_cvt_pk_bf16_f32 v38, 0, v38
    v_cvt_pk_bf16_f32 v39, 0, v39
    v_add_f32 v36, s38, v36
    v_add_f32 v37, s38, v37
    v_add_f32 v38, s38, v38
    v_add_f32 v39, s38, v39
    v_cvt_pk_bf16_f32 v56, v36, v37
    v_cvt_pk_bf16_f32 v57, v38, v39
    s_nop 1
    v_mfma_f32_16x16x16_bf16 v[96:99], v[56:57], v[8:9], 0
    v_mfma_f32_16x16x16_bf16 v[16:19], v[56:57], v[8:9], v[16:19]
    s_nop 6
    v_and_b32 v48, s36, v96
    v_and_b32 v49, s36, v97
    v_and_b32 v50, s36, v98
    v_and_b32 v51, s36, v99
    v_sub_f32 v48, v96, v48
    v_sub_f32 v49, v97, v49
    v_sub_f32 v50, v98, v50
    v_sub_f32 v51, v99, v51
    v_perm_b32 v60, v96, v48, v4
    v_perm_b32 v61, v96, v48, v5
    v_perm_b32 v62, v96, v48, v6
    v_perm_b32 v63, v96, v48, v7
    v_perm_b32 v64, v97, v49, v4
    v_perm_b32 v65, v97, v49, v5
    v_perm_b32 v66, v97, v49, v6
    v_perm_b32 v67, v97, v49, v7
    v_perm_b32 v68, v98, v50, v4
    v_perm_b32 v69, v98, v50, v5
    v_perm_b32 v70, v98, v50, v6
    v_perm_b32 v71, v98, v50, v7
    v_perm_b32 v72, v99, v51, v4
    v_perm_b32 v73, v99, v51, v5
    v_perm_b32 v74, v99, v51, v6
    v_perm_b32 v75, v99, v51, v7
    s_waitcnt vmcnt(11)
    s_add_u32 s56, s56, 131072
    s_and_b32 s56, s56, 2097151
    s_add_u32 s68, s58, s56
    s_add_u32 s65, s65, 0x4000
    s_and_b32 s65, s65, 0x1ffff
    s_add_u32 s68, s68, s65
    buffer_load_dwordx4 v[104:107], v1, s[20:23], s68 offen offset:0 nt
    v_mfma_f32_16x16x32_bf16 v[12:15], v[60:63], a[0:3], v[12:15]
    s_waitcnt vmcnt(11)
    buffer_load_dwordx4 v[108:111], v1, s[20:23], s68 offen offset:64 nt
    v_mfma_f32_16x16x32_bf16 v[12:15], v[64:67], a[4:7], v[12:15]
    s_waitcnt vmcnt(11)
    buffer_load_dwordx4 v[112:115], v1, s[20:23], s68 offen offset:128 nt
    v_mfma_f32_16x16x32_bf16 v[12:15], v[68:71], a[8:11], v[12:15]
    s_waitcnt vmcnt(11)
    s_mov_b64 exec, 3
    global_load_dword v91, v85, s[16:17] offset:4 sc0 sc1
    s_mov_b64 exec, -1
    buffer_load_dwordx4 v[116:119], v1, s[20:23], s68 offen offset:192 nt
    v_mfma_f32_16x16x32_bf16 v[12:15], v[72:75], a[12:15], v[12:15]
    s_waitcnt vmcnt(12)
    buffer_load_dwordx4 a[0:3], v2, s[24:27], s68 offen offset:0 nt
    v_lshlrev_b32 v48, 16, v120
    v_and_b32 v49, s36, v120
    v_lshlrev_b32 v50, 16, v121
    v_and_b32 v51, s36, v121
    v_lshlrev_b32 v52, 16, v122
    v_and_b32 v53, s36, v122
    v_lshlrev_b32 v54, 16, v123
    v_and_b32 v55, s36, v123
    v_pk_mul_f32 v[48:49], v[48:49], s[34:35]
    v_pk_mul_f32 v[50:51], v[50:51], s[34:35]
    v_pk_mul_f32 v[52:53], v[52:53], s[34:35]
    v_pk_mul_f32 v[54:55], v[54:55], s[34:35]
    v_cvt_pk_bf16_f32 v120, v48, v49
    v_cvt_pk_bf16_f32 v121, v50, v51
    v_cvt_pk_bf16_f32 v122, v52, v53
    v_cvt_pk_bf16_f32 v123, v54, v55
    s_waitcnt vmcnt(12)
    buffer_load_dwordx4 a[4:7], v2, s[24:27], s68 offen offset:256 nt
    v_lshlrev_b32 v48, 16, v124
    v_and_b32 v49, s36, v124
    v_lshlrev_b32 v50, 16, v125
    v_and_b32 v51, s36, v125
    v_lshlrev_b32 v52, 16, v126
    v_and_b32 v53, s36, v126
    v_lshlrev_b32 v54, 16, v127
    v_and_b32 v55, s36, v127
    v_pk_mul_f32 v[48:49], v[48:49], s[34:35]
    v_pk_mul_f32 v[50:51], v[50:51], s[34:35]
    v_pk_mul_f32 v[52:53], v[52:53], s[34:35]
    v_pk_mul_f32 v[54:55], v[54:55], s[34:35]
    v_cvt_pk_bf16_f32 v124, v48, v49
    v_cvt_pk_bf16_f32 v125, v50, v51
    v_cvt_pk_bf16_f32 v126, v52, v53
    v_cvt_pk_bf16_f32 v127, v54, v55
    v_mfma_f32_16x16x32_bf16 v[40:43], v[120:123], v[120:123], 0
    v_mfma_f32_16x16x32_bf16 v[36:39], v[20:23], v[120:123], 0
    s_waitcnt vmcnt(12)
    buffer_load_dwordx4 a[8:11], v2, s[24:27], s68 offen offset:512 nt
    v_lshlrev_b32 v48, 16, v128
    v_and_b32 v49, s36, v128
    v_lshlrev_b32 v50, 16, v129
    v_and_b32 v51, s36, v129
    v_lshlrev_b32 v52, 16, v130
    v_and_b32 v53, s36, v130
    v_lshlrev_b32 v54, 16, v131
    v_and_b32 v55, s36, v131
    v_pk_mul_f32 v[48:49], v[48:49], s[34:35]
    v_pk_mul_f32 v[50:51], v[50:51], s[34:35]
    v_pk_mul_f32 v[52:53], v[52:53], s[34:35]
    v_pk_mul_f32 v[54:55], v[54:55], s[34:35]
    v_cvt_pk_bf16_f32 v128, v48, v49
    v_cvt_pk_bf16_f32 v129, v50, v51
    v_cvt_pk_bf16_f32 v130, v52, v53
    v_cvt_pk_bf16_f32 v131, v54, v55
    v_mfma_f32_16x16x32_bf16 v[40:43], v[124:127], v[124:127], v[40:43]
    v_mfma_f32_16x16x32_bf16 v[36:39], v[24:27], v[124:127], v[36:39]
    s_waitcnt vmcnt(12)
    buffer_load_dwordx4 a[12:15], v2, s[24:27], s68 offen offset:768 nt
    v_lshlrev_b32 v48, 16, v132
    v_and_b32 v49, s36, v132
    v_lshlrev_b32 v50, 16, v133
    v_and_b32 v51, s36, v133
    v_lshlrev_b32 v52, 16, v134
    v_and_b32 v53, s36, v134
    v_lshlrev_b32 v54, 16, v135
    v_and_b32 v55, s36, v135
    v_pk_mul_f32 v[48:49], v[48:49], s[34:35]
    v_pk_mul_f32 v[50:51], v[50:51], s[34:35]
    v_pk_mul_f32 v[52:53], v[52:53], s[34:35]
    v_pk_mul_f32 v[54:55], v[54:55], s[34:35]
    v_cvt_pk_bf16_f32 v132, v48, v49
    v_cvt_pk_bf16_f32 v133, v50, v51
    v_cvt_pk_bf16_f32 v134, v52, v53
    v_cvt_pk_bf16_f32 v135, v54, v55
    v_mfma_f32_16x16x32_bf16 v[40:43], v[128:131], v[128:131], v[40:43]
    v_mfma_f32_16x16x32_bf16 v[36:39], v[28:31], v[128:131], v[36:39]
    v_mfma_f32_16x16x32_bf16 v[40:43], v[132:135], v[132:135], v[40:43]
    v_mfma_f32_16x16x32_bf16 v[36:39], v[32:35], v[132:135], v[36:39]
    s_nop 6
    v_cndmask_b32 v10, 0, v40, s[48:49]
    v_cndmask_b32 v10, v10, v41, s[50:51]
    v_cndmask_b32 v10, v10, v42, s[52:53]
    v_cndmask_b32 v10, v10, v43, s[54:55]
    s_nop 1
    v_mfma_f32_16x16x4_f32 v[44:47], v3, v10, 0
    v_cvt_pk_bf16_f32 v36, 0, v36
    v_cvt_pk_bf16_f32 v37, 0, v37
    v_cvt_pk_bf16_f32 v38, 0, v38
    v_cvt_pk_bf16_f32 v39, 0, v39
    s_nop 5
    v_cvt_pk_bf16_f32 v11, 0, v44
    v_fma_f32 v36, v11, -0.5, v36
    v_fma_f32 v37, v11, -0.5, v37
    v_fma_f32 v38, v11, -0.5, v38
    v_fma_f32 v39, v11, -0.5, v39
    v_cvt_pk_bf16_f32 v36, 0, v36
    v_cvt_pk_bf16_f32 v37, 0, v37
    v_cvt_pk_bf16_f32 v38, 0, v38
    v_cvt_pk_bf16_f32 v39, 0, v39
    v_fma_f32 v36, v36, s37, -2.0
    v_fma_f32 v37, v37, s37, -2.0
    v_fma_f32 v38, v38, s37, -2.0
    v_fma_f32 v39, v39, s37, -2.0
    v_exp_f32 v36, v36
    v_exp_f32 v37, v37
    v_exp_f32 v38, v38
    v_exp_f32 v39, v39
    v_cvt_pk_bf16_f32 v36, 0, v36
    v_cvt_pk_bf16_f32 v37, 0, v37
    v_cvt_pk_bf16_f32 v38, 0, v38
    v_cvt_pk_bf16_f32 v39, 0, v39
    v_add_f32 v36, s38, v36
    v_add_f32 v37, s38, v37
    v_add_f32 v38, s38, v38
    v_add_f32 v39, s38, v39
    v_cvt_pk_bf16_f32 v56, v36, v37
    v_cvt_pk_bf16_f32 v57, v38, v39
    s_nop 1
    v_mfma_f32_16x16x16_bf16 v[100:103], v[56:57], v[8:9], 0
    v_mfma_f32_16x16x16_bf16 v[16:19], v[56:57], v[8:9], v[16:19]
    s_nop 6
    v_and_b32 v48, s36, v100
    v_and_b32 v49, s36, v101
    v_and_b32 v50, s36, v102
    v_and_b32 v51, s36, v103
    v_sub_f32 v48, v100, v48
    v_sub_f32 v49, v101, v49
    v_sub_f32 v50, v102, v50
    v_sub_f32 v51, v103, v51
    v_perm_b32 v60, v100, v48, v4
    v_perm_b32 v61, v100, v48, v5
    v_perm_b32 v62, v100, v48, v6
    v_perm_b32 v63, v100, v48, v7
    v_perm_b32 v64, v101, v49, v4
    v_perm_b32 v65, v101, v49, v5
    v_perm_b32 v66, v101, v49, v6
    v_perm_b32 v67, v101, v49, v7
    v_perm_b32 v68, v102, v50, v4
    v_perm_b32 v69, v102, v50, v5
    v_perm_b32 v70, v102, v50, v6
    v_perm_b32 v71, v102, v50, v7
    v_perm_b32 v72, v103, v51, v4
    v_perm_b32 v73, v103, v51, v5
    v_perm_b32 v74, v103, v51, v6
    v_perm_b32 v75, v103, v51, v7
    s_waitcnt vmcnt(12)
    s_add_u32 s56, s56, 131072
    s_and_b32 s56, s56, 2097151
    s_add_u32 s69, s58, s56
    s_add_u32 s65, s65, 0x4000
    s_and_b32 s65, s65, 0x1ffff
    s_add_u32 s69, s69, s65
    buffer_load_dwordx4 v[120:123], v1, s[20:23], s69 offen offset:0 nt
    v_mfma_f32_16x16x32_bf16 v[12:15], v[60:63], a[16:19], v[12:15]
    s_waitcnt vmcnt(12)
    buffer_load_dwordx4 v[124:127], v1, s[20:23], s69 offen offset:64 nt
    v_mfma_f32_16x16x32_bf16 v[12:15], v[64:67], a[20:23], v[12:15]
    s_waitcnt vmcnt(12)
    buffer_load_dwordx4 v[128:131], v1, s[20:23], s69 offen offset:128 nt
    v_mfma_f32_16x16x32_bf16 v[12:15], v[68:71], a[24:27], v[12:15]
    s_waitcnt vmcnt(12)
    buffer_load_dwordx4 v[132:135], v1, s[20:23], s69 offen offset:192 nt
    v_mfma_f32_16x16x32_bf16 v[12:15], v[72:75], a[28:31], v[12:15]
    s_waitcnt vmcnt(12)
    v_lshlrev_b32 v48, 16, v104
    v_and_b32 v49, s36, v104
    v_lshlrev_b32 v50, 16, v105
    v_and_b32 v51, s36, v105
    v_lshlrev_b32 v52, 16, v106
    v_and_b32 v53, s36, v106
    v_lshlrev_b32 v54, 16, v107
    v_and_b32 v55, s36, v107
    v_pk_mul_f32 v[48:49], v[48:49], s[34:35]
    v_pk_mul_f32 v[50:51], v[50:51], s[34:35]
    v_pk_mul_f32 v[52:53], v[52:53], s[34:35]
    v_pk_mul_f32 v[54:55], v[54:55], s[34:35]
    v_cvt_pk_bf16_f32 v104, v48, v49
    v_cvt_pk_bf16_f32 v105, v50, v51
    v_cvt_pk_bf16_f32 v106, v52, v53
    v_cvt_pk_bf16_f32 v107, v54, v55
    s_waitcnt vmcnt(11)
    v_lshlrev_b32 v48, 16, v108
    v_and_b32 v49, s36, v108
    v_lshlrev_b32 v50, 16, v109
    v_and_b32 v51, s36, v109
    v_lshlrev_b32 v52, 16, v110
    v_and_b32 v53, s36, v110
    v_lshlrev_b32 v54, 16, v111
    v_and_b32 v55, s36, v111
    v_pk_mul_f32 v[48:49], v[48:49], s[34:35]
    v_pk_mul_f32 v[50:51], v[50:51], s[34:35]
    v_pk_mul_f32 v[52:53], v[52:53], s[34:35]
    v_pk_mul_f32 v[54:55], v[54:55], s[34:35]
    v_cvt_pk_bf16_f32 v108, v48, v49
    v_cvt_pk_bf16_f32 v109, v50, v51
    v_cvt_pk_bf16_f32 v110, v52, v53
    v_cvt_pk_bf16_f32 v111, v54, v55
    v_mfma_f32_16x16x32_bf16 v[40:43], v[104:107], v[104:107], 0
    v_mfma_f32_16x16x32_bf16 v[36:39], v[20:23], v[104:107], 0
    s_waitcnt vmcnt(10)
    v_lshlrev_b32 v48, 16, v112
    v_and_b32 v49, s36, v112
    v_lshlrev_b32 v50, 16, v113
    v_and_b32 v51, s36, v113
    v_lshlrev_b32 v52, 16, v114
    v_and_b32 v53, s36, v114
    v_lshlrev_b32 v54, 16, v115
    v_and_b32 v55, s36, v115
    v_pk_mul_f32 v[48:49], v[48:49], s[34:35]
    v_pk_mul_f32 v[50:51], v[50:51], s[34:35]
    v_pk_mul_f32 v[52:53], v[52:53], s[34:35]
    v_pk_mul_f32 v[54:55], v[54:55], s[34:35]
    v_cvt_pk_bf16_f32 v112, v48, v49
    v_cvt_pk_bf16_f32 v113, v50, v51
    v_cvt_pk_bf16_f32 v114, v52, v53
    v_cvt_pk_bf16_f32 v115, v54, v55
    v_mfma_f32_16x16x32_bf16 v[40:43], v[108:111], v[108:111], v[40:43]
    v_mfma_f32_16x16x32_bf16 v[36:39], v[24:27], v[108:111], v[36:39]
    s_waitcnt vmcnt(8)
    buffer_load_dwordx4 a[16:19], v2, s[24:27], s69 offen offset:0 nt
    v_lshlrev_b32 v48, 16, v116
    v_and_b32 v49, s36, v116
    v_lshlrev_b32 v50, 16, v117
    v_and_b32 v51, s36, v117
    v_lshlrev_b32 v52, 16, v118
    v_and_b32 v53, s36, v118
    v_lshlrev_b32 v54, 16, v119
    v_and_b32 v55, s36, v119
    v_pk_mul_f32 v[48:49], v[48:49], s[34:35]
    v_pk_mul_f32 v[50:51], v[50:51], s[34:35]
    v_pk_mul_f32 v[52:53], v[52:53], s[34:35]
    v_pk_mul_f32 v[54:55], v[54:55], s[34:35]
    v_cvt_pk_bf16_f32 v116, v48, v49
    v_cvt_pk_bf16_f32 v117, v50, v51
    v_cvt_pk_bf16_f32 v118, v52, v53
    v_cvt_pk_bf16_f32 v119, v54, v55
    v_mfma_f32_16x16x32_bf16 v[40:43], v[112:115], v[112:115], v[40:43]
    v_mfma_f32_16x16x32_bf16 v[36:39], v[28:31], v[112:115], v[36:39]
    v_mfma_f32_16x16x32_bf16 v[40:43], v[116:119], v[116:119], v[40:43]
    v_mfma_f32_16x16x32_bf16 v[36:39], v[32:35], v[116:119], v[36:39]
    s_nop 6
    v_cndmask_b32 v10, 0, v40, s[48:49]
    v_cndmask_b32 v10, v10, v41, s[50:51]
    v_cndmask_b32 v10, v10, v42, s[52:53]
    v_cndmask_b32 v10, v10, v43, s[54:55]
    s_nop 1
    v_mfma_f32_16x16x4_f32 v[44:47], v3, v10, 0
    v_cvt_pk_bf16_f32 v36, 0, v36
    v_cvt_pk_bf16_f32 v37, 0, v37
    v_cvt_pk_bf16_f32 v38, 0, v38
    v_cvt_pk_bf16_f32 v39, 0, v39
    s_nop 5
    v_cvt_pk_bf16_f32 v11, 0, v44
    v_fma_f32 v36, v11, -0.5, v36
    v_fma_f32 v37, v11, -0.5, v37
    v_fma_f32 v38, v11, -0.5, v38
    v_fma_f32 v39, v11, -0.5, v39
    v_cvt_pk_bf16_f32 v36, 0, v36
    v_cvt_pk_bf16_f32 v37, 0, v37
    v_cvt_pk_bf16_f32 v38, 0, v38
    v_cvt_pk_bf16_f32 v39, 0, v39
    v_fma_f32 v36, v36, s37, -2.0
    v_fma_f32 v37, v37, s37, -2.0
    v_fma_f32 v38, v38, s37, -2.0
    v_fma_f32 v39, v39, s37, -2.0
    v_exp_f32 v36, v36
    v_exp_f32 v37, v37
    v_exp_f32 v38, v38
    v_exp_f32 v39, v39
    v_cvt_pk_bf16_f32 v36, 0, v36
    v_cvt_pk_bf16_f32 v37, 0, v37
    v_cvt_pk_bf16_f32 v38, 0, v38
    v_cvt_pk_bf16_f32 v39, 0, v39
    v_add_f32 v36, s38, v36
    v_add_f32 v37, s38, v37
    v_add_f32 v38, s38, v38
    v_add_f32 v39, s38, v39
    v_cvt_pk_bf16_f32 v56, v36, v37
    v_cvt_pk_bf16_f32 v57, v38, v39
    s_nop 1
    v_mfma_f32_16x16x16_bf16 v[96:99], v[56:57], v[8:9], 0
    v_mfma_f32_16x16x16_bf16 v[16:19], v[56:57], v[8:9], v[16:19]
    s_nop 6
    v_and_b32 v48, s36, v96
    v_and_b32 v49, s36, v97
    v_and_b32 v50, s36, v98
    v_and_b32 v51, s36, v99
    v_sub_f32 v48, v96, v48
    v_sub_f32 v49, v97, v49
    v_sub_f32 v50, v98, v50
    v_sub_f32 v51, v99, v51
    v_perm_b32 v60, v96, v48, v4
    v_perm_b32 v61, v96, v48, v5
    v_perm_b32 v62, v96, v48, v6
    v_perm_b32 v63, v96, v48, v7
    v_perm_b32 v64, v97, v49, v4
    v_perm_b32 v65, v97, v49, v5
    v_perm_b32 v66, v97, v49, v6
    v_perm_b32 v67, v97, v49, v7
    v_perm_b32 v68, v98, v50, v4
    v_perm_b32 v69, v98, v50, v5
    v_perm_b32 v70, v98, v50, v6
    v_perm_b32 v71, v98, v50, v7
    v_perm_b32 v72, v99, v51, v4
    v_perm_b32 v73, v99, v51, v5
    v_perm_b32 v74, v99, v51, v6
    v_perm_b32 v75, v99, v51, v7
    s_waitcnt vmcnt(8)
    buffer_load_dwordx4 a[20:23], v2, s[24:27], s69 offen offset:256 nt
    v_mfma_f32_16x16x32_bf16 v[12:15], v[60:63], a[0:3], v[12:15]
    s_waitcnt vmcnt(8)
    buffer_load_dwordx4 a[24:27], v2, s[24:27], s69 offen offset:512 nt
    v_mfma_f32_16x16x32_bf16 v[12:15], v[64:67], a[4:7], v[12:15]
    s_waitcnt vmcnt(8)
    v_readfirstlane_b32 s63, v91
    v_readlane_b32 s64, v91, 1
    s_xor_b32 s63, s63, s57
    s_xor_b32 s64, s64, s57
    s_or_b32 s63, s63, s64
    s_cbranch_scc1 L_slow
L_back:
    s_mov_b64 exec, 1
    global_atomic_add v89, v85, v86, s[16:17] sc0 sc1
    s_mov_b64 exec, -1
    buffer_load_dwordx4 a[28:31], v2, s[24:27], s69 offen offset:768 nt
    v_mfma_f32_16x16x32_bf16 v[12:15], v[68:71], a[8:11], v[12:15]
    s_waitcnt vmcnt(9)
    s_add_u32 s56, s56, 131072
    s_and_b32 s56, s56, 2097151
    s_add_u32 s68, s58, s56
    s_add_u32 s65, s65, 0x4000
    s_and_b32 s65, s65, 0x1ffff
    s_add_u32 s68, s68, s65
    buffer_load_dwordx4 v[104:107], v1, s[20:23], s68 offen offset:0 nt
    v_mfma_f32_16x16x32_bf16 v[12:15], v[72:75], a[12:15], v[12:15]
    s_waitcnt vmcnt(9)
    buffer_load_dwordx4 v[108:111], v1, s[20:23], s68 offen offset:64 nt
    v_lshlrev_b32 v48, 16, v120
    v_and_b32 v49, s36, v120
    v_lshlrev_b32 v50, 16, v121
    v_and_b32 v51, s36, v121
    v_lshlrev_b32 v52, 16, v122
    v_and_b32 v53, s36, v122
    v_lshlrev_b32 v54, 16, v123
    v_and_b32 v55, s36, v123
    v_pk_mul_f32 v[48:49], v[48:49], s[34:35]
    v_pk_mul_f32 v[50:51], v[50:51], s[34:35]
    v_pk_mul_f32 v[52:53], v[52:53], s[34:35]
    v_pk_mul_f32 v[54:55], v[54:55], s[34:35]
    v_cvt_pk_bf16_f32 v120, v48, v49
    v_cvt_pk_bf16_f32 v121, v50, v51
    v_cvt_pk_bf16_f32 v122, v52, v53
    v_cvt_pk_bf16_f32 v123, v54, v55
    s_waitcnt vmcnt(9)
    buffer_load_dwordx4 v[112:115], v1, s[20:23], s68 offen offset:128 nt
    v_lshlrev_b32 v48, 16, v124
    v_and_b32 v49, s36, v124
    v_lshlrev_b32 v50, 16, v125
    v_and_b32 v51, s36, v125
    v_lshlrev_b32 v52, 16, v126
    v_and_b32 v53, s36, v126
    v_lshlrev_b32 v54, 16, v127
    v_and_b32 v55, s36, v127
    v_pk_mul_f32 v[48:49], v[48:49], s[34:35]
    v_pk_mul_f32 v[50:51], v[50:51], s[34:35]
    v_pk_mul_f32 v[52:53], v[52:53], s[34:35]
    v_pk_mul_f32 v[54:55], v[54:55], s[34:35]
    v_cvt_pk_bf16_f32 v124, v48, v49
    v_cvt_pk_bf16_f32 v125, v50, v51
    v_cvt_pk_bf16_f32 v126, v52, v53
    v_cvt_pk_bf16_f32 v127, v54, v55
    v_mfma_f32_16x16x32_bf16 v[40:43], v[120:123], v[120:123], 0
    v_mfma_f32_16x16x32_bf16 v[36:39], v[20:23], v[120:123], 0
    s_waitcnt vmcnt(9)
    buffer_load_dwordx4 v[116:119], v1, s[20:23], s68 offen offset:192 nt
    v_lshlrev_b32 v48, 16, v128
    v_and_b32 v49, s36, v128
    v_lshlrev_b32 v50, 16, v129
    v_and_b32 v51, s36, v129
    v_lshlrev_b32 v52, 16, v130
    v_and_b32 v53, s36, v130
    v_lshlrev_b32 v54, 16, v131
    v_and_b32 v55, s36, v131
    v_pk_mul_f32 v[48:49], v[48:49], s[34:35]
    v_pk_mul_f32 v[50:51], v[50:51], s[34:35]
    v_pk_mul_f32 v[52:53], v[52:53], s[34:35]
    v_pk_mul_f32 v[54:55], v[54:55], s[34:35]
    v_cvt_pk_bf16_f32 v128, v48, v49
    v_cvt_pk_bf16_f32 v129, v50, v51
    v_cvt_pk_bf16_f32 v130, v52, v53
    v_cvt_pk_bf16_f32 v131, v54, v55
    v_mfma_f32_16x16x32_bf16 v[40:43], v[124:127], v[124:127], v[40:43]
    v_mfma_f32_16x16x32_bf16 v[36:39], v[24:27], v[124:127], v[36:39]
    s_waitcnt vmcnt(9)
    buffer_load_dwordx4 a[0:3], v2, s[24:27], s68 offen offset:0 nt
    v_lshlrev_b32 v48, 16, v132
    v_and_b32 v49, s36, v132
    v_lshlrev_b32 v50, 16, v133
    v_and_b32 v51, s36, v133
    v_lshlrev_b32 v52, 16, v134
    v_and_b32 v53, s36, v134
    v_lshlrev_b32 v54, 16, v135
    v_and_b32 v55, s36, v135
    v_pk_mul_f32 v[48:49], v[48:49], s[34:35]
    v_pk_mul_f32 v[50:51], v[50:51], s[34:35]
    v_pk_mul_f32 v[52:53], v[52:53], s[34:35]
    v_pk_mul_f32 v[54:55], v[54:55], s[34:35]
    v_cvt_pk_bf16_f32 v132, v48, v49
    v_cvt_pk_bf16_f32 v133, v50, v51
    v_cvt_pk_bf16_f32 v134, v52, v53
    v_cvt_pk_bf16_f32 v135, v54, v55
    v_mfma_f32_16x16x32_bf16 v[40:43], v[128:131], v[128:131], v[40:43]
    v_mfma_f32_16x16x32_bf16 v[36:39], v[28:31], v[128:131], v[36:39]
    v_mfma_f32_16x16x32_bf16 v[40:43], v[132:135], v[132:135], v[40:43]
    v_mfma_f32_16x16x32_bf16 v[36:39], v[32:35], v[132:135], v[36:39]
    s_nop 6
    v_cndmask_b32 v10, 0, v40, s[48:49]
    v_cndmask_b32 v10, v10, v41, s[50:51]
    v_cndmask_b32 v10, v10, v42, s[52:53]
    v_cndmask_b32 v10, v10, v43, s[54:55]
    s_nop 1
    v_mfma_f32_16x16x4_f32 v[44:47], v3, v10, 0
    v_cvt_pk_bf16_f32 v36, 0, v36
    v_cvt_pk_bf16_f32 v37, 0, v37
    v_cvt_pk_bf16_f32 v38, 0, v38
    v_cvt_pk_bf16_f32 v39, 0, v39
    s_nop 5
    v_cvt_pk_bf16_f32 v11, 0, v44
    v_fma_f32 v36, v11, -0.5, v36
    v_fma_f32 v37, v11, -0.5, v37
    v_fma_f32 v38, v11, -0.5, v38
    v_fma_f32 v39, v11, -0.5, v39
    v_cvt_pk_bf16_f32 v36, 0, v36
    v_cvt_pk_bf16_f32 v37, 0, v37
    v_cvt_pk_bf16_f32 v38, 0, v38
    v_cvt_pk_bf16_f32 v39, 0, v39
    v_fma_f32 v36, v36, s37, -2.0
    v_fma_f32 v37, v37, s37, -2.0
    v_fma_f32 v38, v38, s37, -2.0
    v_fma_f32 v39, v39, s37, -2.0
    v_exp_f32 v36, v36
    v_exp_f32 v37, v37
    v_exp_f32 v38, v38
    v_exp_f32 v39, v39
    v_cvt_pk_bf16_f32 v36, 0, v36
    v_cvt_pk_bf16_f32 v37, 0, v37
    v_cvt_pk_bf16_f32 v38, 0, v38
    v_cvt_pk_bf16_f32 v39, 0, v39
    v_add_f32 v36, s38, v36
    v_add_f32 v37, s38, v37
    v_add_f32 v38, s38, v38
    v_add_f32 v39, s38, v39
    v_cvt_pk_bf16_f32 v56, v36, v37
    v_cvt_pk_bf16_f32 v57, v38, v39
    s_nop 1
    v_mfma_f32_16x16x16_bf16 v[100:103], v[56:57], v[8:9], 0
    v_mfma_f32_16x16x16_bf16 v[16:19], v[56:57], v[8:9], v[16:19]
    s_nop 6
    v_and_b32 v48, s36, v100
    v_and_b32 v49, s36, v101
    v_and_b32 v50, s36, v102
    v_and_b32 v51, s36, v103
    v_sub_f32 v48, v100, v48
    v_sub_f32 v49, v101, v49
    v_sub_f32 v50, v102, v50
    v_sub_f32 v51, v103, v51
    v_perm_b32 v60, v100, v48, v4
    v_perm_b32 v61, v100, v48, v5
    v_perm_b32 v62, v100, v48, v6
    v_perm_b32 v63, v100, v48, v7
    v_perm_b32 v64, v101, v49, v4
    v_perm_b32 v65, v101, v49, v5
    v_perm_b32 v66, v101, v49, v6
    v_perm_b32 v67, v101, v49, v7
    v_perm_b32 v68, v102, v50, v4
    v_perm_b32 v69, v102, v50, v5
    v_perm_b32 v70, v102, v50, v6
    v_perm_b32 v71, v102, v50, v7
    v_perm_b32 v72, v103, v51, v4
    v_perm_b32 v73, v103, v51, v5
    v_perm_b32 v74, v103, v51, v6
    v_perm_b32 v75, v103, v51, v7
    s_waitcnt vmcnt(9)
    buffer_load_dwordx4 a[4:7], v2, s[24:27], s68 offen offset:256 nt
    v_mfma_f32_16x16x32_bf16 v[12:15], v[60:63], a[16:19], v[12:15]
    s_waitcnt vmcnt(9)
    buffer_load_dwordx4 a[8:11], v2, s[24:27], s68 offen offset:512 nt
    v_mfma_f32_16x16x32_bf16 v[12:15], v[64:67], a[20:23], v[12:15]
    s_waitcnt vmcnt(9)
    s_mov_b64 exec, 1
    global_atomic_add v88, v85, v86, s[16:17] sc0 sc1
    s_mov_b64 exec, -1
    buffer_load_dwordx4 a[12:15], v2, s[24:27], s68 offen offset:768 nt
    v_mfma_f32_16x16x32_bf16 v[12:15], v[68:71], a[24:27], v[12:15]
    s_waitcnt vmcnt(9)
    v_readfirstlane_b32 s62, v89
    s_nop 0
    s_lshr_b32 s63, s62, 5
    s_add_u32 s63, s63, s60
    s_and_b32 s63, s63, 15
    s_lshl_b32 s63, s63, 17
    s_and_b32 s64, s62, 31
    s_lshl_b32 s64, s64, 12
    s_add_u32 s63, s63, s61
    s_add_u32 s63, s63, s64
    s_cmp_lt_u32 s62, 32
    s_cselect_b32 s69, s63, 0x80000000
    buffer_load_dwordx4 v[120:123], v1, s[20:23], s69 offen offset:0 nt
    v_mfma_f32_16x16x32_bf16 v[12:15], v[72:75], a[28:31], v[12:15]
    s_waitcnt vmcnt(9)
    buffer_load_dwordx4 v[124:127], v1, s[20:23], s69 offen offset:64 nt
    v_lshlrev_b32 v48, 16, v104
    v_and_b32 v49, s36, v104
    v_lshlrev_b32 v50, 16, v105
    v_and_b32 v51, s36, v105
    v_lshlrev_b32 v52, 16, v106
    v_and_b32 v53, s36, v106
    v_lshlrev_b32 v54, 16, v107
    v_and_b32 v55, s36, v107
    v_pk_mul_f32 v[48:49], v[48:49], s[34:35]
    v_pk_mul_f32 v[50:51], v[50:51], s[34:35]
    v_pk_mul_f32 v[52:53], v[52:53], s[34:35]
    v_pk_mul_f32 v[54:55], v[54:55], s[34:35]
    v_cvt_pk_bf16_f32 v104, v48, v49
    v_cvt_pk_bf16_f32 v105, v50, v51
    v_cvt_pk_bf16_f32 v106, v52, v53
    v_cvt_pk_bf16_f32 v107, v54, v55
    s_waitcnt vmcnt(9)
    buffer_load_dwordx4 v[128:131], v1, s[20:23], s69 offen offset:128 nt
    v_lshlrev_b32 v48, 16, v108
    v_and_b32 v49, s36, v108
    v_lshlrev_b32 v50, 16, v109
    v_and_b32 v51, s36, v109
    v_lshlrev_b32 v52, 16, v110
    v_and_b32 v53, s36, v110
    v_lshlrev_b32 v54, 16, v111
    v_and_b32 v55, s36, v111
    v_pk_mul_f32 v[48:49], v[48:49], s[34:35]
    v_pk_mul_f32 v[50:51], v[50:51], s[34:35]
    v_pk_mul_f32 v[52:53], v[52:53], s[34:35]
    v_pk_mul_f32 v[54:55], v[54:55], s[34:35]
    v_cvt_pk_bf16_f32 v108, v48, v49
    v_cvt_pk_bf16_f32 v109, v50, v51
    v_cvt_pk_bf16_f32 v110, v52, v53
    v_cvt_pk_bf16_f32 v111, v54, v55
    v_mfma_f32_16x16x32_bf16 v[40:43], v[104:107], v[104:107], 0
    v_mfma_f32_16x16x32_bf16 v[36:39], v[20:23], v[104:107], 0
    s_waitcnt vmcnt(9)
    buffer_load_dwordx4 v[132:135], v1, s[20:23], s69 offen offset:192 nt
    v_lshlrev_b32 v48, 16, v112
    v_and_b32 v49, s36, v112
    v_lshlrev_b32 v50, 16, v113
    v_and_b32 v51, s36, v113
    v_lshlrev_b32 v52, 16, v114
    v_and_b32 v53, s36, v114
    v_lshlrev_b32 v54, 16, v115
    v_and_b32 v55, s36, v115
    v_pk_mul_f32 v[48:49], v[48:49], s[34:35]
    v_pk_mul_f32 v[50:51], v[50:51], s[34:35]
    v_pk_mul_f32 v[52:53], v[52:53], s[34:35]
    v_pk_mul_f32 v[54:55], v[54:55], s[34:35]
    v_cvt_pk_bf16_f32 v112, v48, v49
    v_cvt_pk_bf16_f32 v113, v50, v51
    v_cvt_pk_bf16_f32 v114, v52, v53
    v_cvt_pk_bf16_f32 v115, v54, v55
    v_mfma_f32_16x16x32_bf16 v[40:43], v[108:111], v[108:111], v[40:43]
    v_mfma_f32_16x16x32_bf16 v[36:39], v[24:27], v[108:111], v[36:39]
    s_waitcnt vmcnt(9)
    buffer_load_dwordx4 a[16:19], v2, s[24:27], s69 offen offset:0 nt
    v_lshlrev_b32 v48, 16, v116
    v_and_b32 v49, s36, v116
    v_lshlrev_b32 v50, 16, v117
    v_and_b32 v51, s36, v117
    v_lshlrev_b32 v52, 16, v118
    v_and_b32 v53, s36, v118
    v_lshlrev_b32 v54, 16, v119
    v_and_b32 v55, s36, v119
    v_pk_mul_f32 v[48:49], v[48:49], s[34:35]
    v_pk_mul_f32 v[50:51], v[50:51], s[34:35]
    v_pk_mul_f32 v[52:53], v[52:53], s[34:35]
    v_pk_mul_f32 v[54:55], v[54:55], s[34:35]
    v_cvt_pk_bf16_f32 v116, v48, v49
    v_cvt_pk_bf16_f32 v117, v50, v51
    v_cvt_pk_bf16_f32 v118, v52, v53
    v_cvt_pk_bf16_f32 v119, v54, v55
    v_mfma_f32_16x16x32_bf16 v[40:43], v[112:115], v[112:115], v[40:43]
    v_mfma_f32_16x16x32_bf16 v[36:39], v[28:31], v[112:115], v[36:39]
    v_mfma_f32_16x16x32_bf16 v[40:43], v[116:119], v[116:119], v[40:43]
    v_mfma_f32_16x16x32_bf16 v[36:39], v[32:35], v[116:119], v[36:39]
    s_nop 6
    v_cndmask_b32 v10, 0, v40, s[48:49]
    v_cndmask_b32 v10, v10, v41, s[50:51]
    v_cndmask_b32 v10, v10, v42, s[52:53]
    v_cndmask_b32 v10, v10, v43, s[54:55]
    s_nop 1
    v_mfma_f32_16x16x4_f32 v[44:47], v3, v10, 0
    v_cvt_pk_bf16_f32 v36, 0, v36
    v_cvt_pk_bf16_f32 v37, 0, v37
    v_cvt_pk_bf16_f32 v38, 0, v38
    v_cvt_pk_bf16_f32 v39, 0, v39
    s_nop 5
    v_cvt_pk_bf16_f32 v11, 0, v44
    v_fma_f32 v36, v11, -0.5, v36
    v_fma_f32 v37, v11, -0.5, v37
    v_fma_f32 v38, v11, -0.5, v38
    v_fma_f32 v39, v11, -0.5, v39
    v_cvt_pk_bf16_f32 v36, 0, v36
    v_cvt_pk_bf16_f32 v37, 0, v37
    v_cvt_pk_bf16_f32 v38, 0, v38
    v_cvt_pk_bf16_f32 v39, 0, v39
    v_fma_f32 v36, v36, s37, -2.0
    v_fma_f32 v37, v37, s37, -2.0
    v_fma_f32 v38, v38, s37, -2.0
    v_fma_f32 v39, v39, s37, -2.0
    v_exp_f32 v36, v36
    v_exp_f32 v37, v37
    v_exp_f32 v38, v38
    v_exp_f32 v39, v39
    v_cvt_pk_bf16_f32 v36, 0, v36
    v_cvt_pk_bf16_f32 v37, 0, v37
    v_cvt_pk_bf16_f32 v38, 0, v38
    v_cvt_pk_bf16_f32 v39, 0, v39
    v_add_f32 v36, s38, v36
    v_add_f32 v37, s38, v37
    v_add_f32 v38, s38, v38
    v_add_f32 v39, s38, v39
    v_cvt_pk_bf16_f32 v56, v36, v37
    v_cvt_pk_bf16_f32 v57, v38, v39
    s_cmp_lt_i32 s69, 0
    s_cbranch_scc0 L_nodecl14_0
    s_mov_b64 exec, 1
    global_atomic_add v87, v85, v86, s[16:17] offset:256 sc0 sc1
    s_mov_b64 exec, -1
L_nodecl14_0:
    v_mfma_f32_16x16x16_bf16 v[96:99], v[56:57], v[8:9], 0
    v_mfma_f32_16x16x16_bf16 v[16:19], v[56:57], v[8:9], v[16:19]
    s_nop 6
    v_and_b32 v48, s36, v96
    v_and_b32 v49, s36, v97
    v_and_b32 v50, s36, v98
    v_and_b32 v51, s36, v99
    v_sub_f32 v48, v96, v48
    v_sub_f32 v49, v97, v49
    v_sub_f32 v50, v98, v50
    v_sub_f32 v51, v99, v51
    v_perm_b32 v60, v96, v48, v4
    v_perm_b32 v61, v96, v48, v5
    v_perm_b32 v62, v96, v48, v6
    v_perm_b32 v63, v96, v48, v7
    v_perm_b32 v64, v97, v49, v4
    v_perm_b32 v65, v97, v49, v5
    v_perm_b32 v66, v97, v49, v6
    v_perm_b32 v67, v97, v49, v7
    v_perm_b32 v68, v98, v50, v4
    v_perm_b32 v69, v98, v50, v5
    v_perm_b32 v70, v98, v50, v6
    v_perm_b32 v71, v98, v50, v7
    v_perm_b32 v72, v99, v51, v4
    v_perm_b32 v73, v99, v51, v5
    v_perm_b32 v74, v99, v51, v6
    v_perm_b32 v75, v99, v51, v7
    s_waitcnt vmcnt(9)
    buffer_load_dwordx4 a[20:23], v2, s[24:27], s69 offen offset:256 nt
    v_mfma_f32_16x16x32_bf16 v[12:15], v[60:63], a[0:3], v[12:15]
    s_waitcnt vmcnt(9)
    buffer_load_dwordx4 a[24:27], v2, s[24:27], s69 offen offset:512 nt
    v_mfma_f32_16x16x32_bf16 v[12:15], v[64:67], a[4:7], v[12:15]
    s_waitcnt vmcnt(9)
    buffer_load_dwordx4 a[28:31], v2, s[24:27], s69 offen offset:768 nt
    v_mfma_f32_16x16x32_bf16 v[12:15], v[68:71], a[8:11], v[12:15]
    s_waitcnt vmcnt(8)
    v_readfirstlane_b32 s62, v88
    s_nop 0
    s_lshr_b32 s63, s62, 5
    s_add_u32 s63, s63, s60
    s_and_b32 s63, s63, 15
    s_lshl_b32 s63, s63, 17
    s_and_b32 s64, s62, 31
    s_lshl_b32 s64, s64, 12
    s_add_u32 s63, s63, s61
    s_add_u32 s63, s63, s64
    s_cmp_lt_u32 s62, 32
    s_cselect_b32 s68, s63, 0x80000000
    buffer_load_dwordx4 v[104:107], v1, s[20:23], s68 offen offset:0 nt
    v_mfma_f32_16x16x32_bf16 v[12:15], v[72:75], a[12:15], v[12:15]
    s_cmp_lt_i32 s69, 0
    s_cbranch_scc1 L_drain15
    s_waitcnt vmcnt(8)
    buffer_load_dwordx4 v[108:111], v1, s[20:23], s68 offen offset:64 nt
    v_lshlrev_b32 v48, 16, v120
    v_and_b32 v49, s36, v120
    v_lshlrev_b32 v50, 16, v121
    v_and_b32 v51, s36, v121
    v_lshlrev_b32 v52, 16, v122
    v_and_b32 v53, s36, v122
    v_lshlrev_b32 v54, 16, v123
    v_and_b32 v55, s36, v123
    v_pk_mul_f32 v[48:49], v[48:49], s[34:35]
    v_pk_mul_f32 v[50:51], v[50:51], s[34:35]
    v_pk_mul_f32 v[52:53], v[52:53], s[34:35]
    v_pk_mul_f32 v[54:55], v[54:55], s[34:35]
    v_cvt_pk_bf16_f32 v120, v48, v49
    v_cvt_pk_bf16_f32 v121, v50, v51
    v_cvt_pk_bf16_f32 v122, v52, v53
    v_cvt_pk_bf16_f32 v123, v54, v55
    s_waitcnt vmcnt(8)
    buffer_load_dwordx4 v[112:115], v1, s[20:23], s68 offen offset:128 nt
    v_lshlrev_b32 v48, 16, v124
    v_and_b32 v49, s36, v124
    v_lshlrev_b32 v50, 16, v125
    v_and_b32 v51, s36, v125
    v_lshlrev_b32 v52, 16, v126
    v_and_b32 v53, s36, v126
    v_lshlrev_b32 v54, 16, v127
    v_and_b32 v55, s36, v127
    v_pk_mul_f32 v[48:49], v[48:49], s[34:35]
    v_pk_mul_f32 v[50:51], v[50:51], s[34:35]
    v_pk_mul_f32 v[52:53], v[52:53], s[34:35]
    v_pk_mul_f32 v[54:55], v[54:55], s[34:35]
    v_cvt_pk_bf16_f32 v124, v48, v49
    v_cvt_pk_bf16_f32 v125, v50, v51
    v_cvt_pk_bf16_f32 v126, v52, v53
    v_cvt_pk_bf16_f32 v127, v54, v55
    v_mfma_f32_16x16x32_bf16 v[40:43], v[120:123], v[120:123], 0
    v_mfma_f32_16x16x32_bf16 v[36:39], v[20:23], v[120:123], 0
    s_waitcnt vmcnt(8)
    buffer_load_dwordx4 v[116:119], v1, s[20:23], s68 offen offset:192 nt
    v_lshlrev_b32 v48, 16, v128
    v_and_b32 v49, s36, v128
    v_lshlrev_b32 v50, 16, v129
    v_and_b32 v51, s36, v129
    v_lshlrev_b32 v52, 16, v130
    v_and_b32 v53, s36, v130
    v_lshlrev_b32 v54, 16, v131
    v_and_b32 v55, s36, v131
    v_pk_mul_f32 v[48:49], v[48:49], s[34:35]
    v_pk_mul_f32 v[50:51], v[50:51], s[34:35]
    v_pk_mul_f32 v[52:53], v[52:53], s[34:35]
    v_pk_mul_f32 v[54:55], v[54:55], s[34:35]
    v_cvt_pk_bf16_f32 v128, v48, v49
    v_cvt_pk_bf16_f32 v129, v50, v51
    v_cvt_pk_bf16_f32 v130, v52, v53
    v_cvt_pk_bf16_f32 v131, v54, v55
    v_mfma_f32_16x16x32_bf16 v[40:43], v[124:127], v[124:127], v[40:43]
    v_mfma_f32_16x16x32_bf16 v[36:39], v[24:27], v[124:127], v[36:39]
    s_waitcnt vmcnt(8)
    buffer_load_dwordx4 a[0:3], v2, s[24:27], s68 offen offset:0 nt
    v_lshlrev_b32 v48, 16, v132
    v_and_b32 v49, s36, v132
    v_lshlrev_b32 v50, 16, v133
    v_and_b32 v51, s36, v133
    v_lshlrev_b32 v52, 16, v134
    v_and_b32 v53, s36, v134
    v_lshlrev_b32 v54, 16, v135
    v_and_b32 v55, s36, v135
    v_pk_mul_f32 v[48:49], v[48:49], s[34:35]
    v_pk_mul_f32 v[50:51], v[50:51], s[34:35]
    v_pk_mul_f32 v[52:53], v[52:53], s[34:35]
    v_pk_mul_f32 v[54:55], v[54:55], s[34:35]
    v_cvt_pk_bf16_f32 v132, v48, v49
    v_cvt_pk_bf16_f32 v133, v50, v51
    v_cvt_pk_bf16_f32 v134, v52, v53
    v_cvt_pk_bf16_f32 v135, v54, v55
    v_mfma_f32_16x16x32_bf16 v[40:43], v[128:131], v[128:131], v[40:43]
    v_mfma_f32_16x16x32_bf16 v[36:39], v[28:31], v[128:131], v[36:39]
    v_mfma_f32_16x16x32_bf16 v[40:43], v[132:135], v[132:135], v[40:43]
    v_mfma_f32_16x16x32_bf16 v[36:39], v[32:35], v[132:135], v[36:39]
    s_nop 6
    v_cndmask_b32 v10, 0, v40, s[48:49]
    v_cndmask_b32 v10, v10, v41, s[50:51]
    v_cndmask_b32 v10, v10, v42, s[52:53]
    v_cndmask_b32 v10, v10, v43, s[54:55]
    s_nop 1
    v_mfma_f32_16x16x4_f32 v[44:47], v3, v10, 0
    v_cvt_pk_bf16_f32 v36, 0, v36
    v_cvt_pk_bf16_f32 v37, 0, v37
    v_cvt_pk_bf16_f32 v38, 0, v38
    v_cvt_pk_bf16_f32 v39, 0, v39
    s_nop 5
    v_cvt_pk_bf16_f32 v11, 0, v44
    v_fma_f32 v36, v11, -0.5, v36
    v_fma_f32 v37, v11, -0.5, v37
    v_fma_f32 v38, v11, -0.5, v38
    v_fma_f32 v39, v11, -0.5, v39
    v_cvt_pk_bf16_f32 v36, 0, v36
    v_cvt_pk_bf16_f32 v37, 0, v37
    v_cvt_pk_bf16_f32 v38, 0, v38
    v_cvt_pk_bf16_f32 v39, 0, v39
    v_fma_f32 v36, v36, s37, -2.0
    v_fma_f32 v37, v37, s37, -2.0
    v_fma_f32 v38, v38, s37, -2.0
    v_fma_f32 v39, v39, s37, -2.0
    v_exp_f32 v36, v36
    v_exp_f32 v37, v37
    v_exp_f32 v38, v38
    v_exp_f32 v39, v39
    v_cvt_pk_bf16_f32 v36, 0, v36
    v_cvt_pk_bf16_f32 v37, 0, v37
    v_cvt_pk_bf16_f32 v38, 0, v38
    v_cvt_pk_bf16_f32 v39, 0, v39
    v_add_f32 v36, s38, v36
    v_add_f32 v37, s38, v37
    v_add_f32 v38, s38, v38
    v_add_f32 v39, s38, v39
    v_cvt_pk_bf16_f32 v56, v36, v37
    v_cvt_pk_bf16_f32 v57, v38, v39
    s_cmp_lt_i32 s68, 0
    s_cbranch_scc0 L_nodecl15_0
    s_mov_b64 exec, 1
    global_atomic_add v87, v85, v86, s[16:17] offset:256 sc0 sc1
    s_mov_b64 exec, -1
L_nodecl15_0:
    v_mfma_f32_16x16x16_bf16 v[100:103], v[56:57], v[8:9], 0
    v_mfma_f32_16x16x16_bf16 v[16:19], v[56:57], v[8:9], v[16:19]
    s_nop 6
    v_and_b32 v48, s36, v100
    v_and_b32 v49, s36, v101
    v_and_b32 v50, s36, v102
    v_and_b32 v51, s36, v103
    v_sub_f32 v48, v100, v48
    v_sub_f32 v49, v101, v49
    v_sub_f32 v50, v102, v50
    v_sub_f32 v51, v103, v51
    v_perm_b32 v60, v100, v48, v4
    v_perm_b32 v61, v100, v48, v5
    v_perm_b32 v62, v100, v48, v6
    v_perm_b32 v63, v100, v48, v7
    v_perm_b32 v64, v101, v49, v4
    v_perm_b32 v65, v101, v49, v5
    v_perm_b32 v66, v101, v49, v6
    v_perm_b32 v67, v101, v49, v7
    v_perm_b32 v68, v102, v50, v4
    v_perm_b32 v69, v102, v50, v5
    v_perm_b32 v70, v102, v50, v6
    v_perm_b32 v71, v102, v50, v7
    v_perm_b32 v72, v103, v51, v4
    v_perm_b32 v73, v103, v51, v5
    v_perm_b32 v74, v103, v51, v6
    v_perm_b32 v75, v103, v51, v7
    s_waitcnt vmcnt(8)
    buffer_load_dwordx4 a[4:7], v2, s[24:27], s68 offen offset:256 nt
    v_mfma_f32_16x16x32_bf16 v[12:15], v[60:63], a[16:19], v[12:15]
    s_waitcnt vmcnt(8)
    buffer_load_dwordx4 a[8:11], v2, s[24:27], s68 offen offset:512 nt
    v_mfma_f32_16x16x32_bf16 v[12:15], v[64:67], a[20:23], v[12:15]
    s_waitcnt vmcnt(8)
    buffer_load_dwordx4 a[12:15], v2, s[24:27], s68 offen offset:768 nt
    v_mfma_f32_16x16x32_bf16 v[12:15], v[68:71], a[24:27], v[12:15]
    s_waitcnt vmcnt(8)
    v_mfma_f32_16x16x32_bf16 v[12:15], v[72:75], a[28:31], v[12:15]
    s_cmp_lt_i32 s68, 0
    s_cbranch_scc1 L_drain16
    s_waitcnt vmcnt(7)
    v_lshlrev_b32 v48, 16, v104
    v_and_b32 v49, s36, v104
    v_lshlrev_b32 v50, 16, v105
    v_and_b32 v51, s36, v105
    v_lshlrev_b32 v52, 16, v106
    v_and_b32 v53, s36, v106
    v_lshlrev_b32 v54, 16, v107
    v_and_b32 v55, s36, v107
    v_pk_mul_f32 v[48:49], v[48:49], s[34:35]
    v_pk_mul_f32 v[50:51], v[50:51], s[34:35]
    v_pk_mul_f32 v[52:53], v[52:53], s[34:35]
    v_pk_mul_f32 v[54:55], v[54:55], s[34:35]
    v_cvt_pk_bf16_f32 v104, v48, v49
    v_cvt_pk_bf16_f32 v105, v50, v51
    v_cvt_pk_bf16_f32 v106, v52, v53
    v_cvt_pk_bf16_f32 v107, v54, v55
    s_waitcnt vmcnt(6)
    v_lshlrev_b32 v48, 16, v108
    v_and_b32 v49, s36, v108
    v_lshlrev_b32 v50, 16, v109
    v_and_b32 v51, s36, v109
    v_lshlrev_b32 v52, 16, v110
    v_and_b32 v53, s36, v110
    v_lshlrev_b32 v54, 16, v111
    v_and_b32 v55, s36, v111
    v_pk_mul_f32 v[48:49], v[48:49], s[34:35]
    v_pk_mul_f32 v[50:51], v[50:51], s[34:35]
    v_pk_mul_f32 v[52:53], v[52:53], s[34:35]
    v_pk_mul_f32 v[54:55], v[54:55], s[34:35]
    v_cvt_pk_bf16_f32 v108, v48, v49
    v_cvt_pk_bf16_f32 v109, v50, v51
    v_cvt_pk_bf16_f32 v110, v52, v53
    v_cvt_pk_bf16_f32 v111, v54, v55
    v_mfma_f32_16x16x32_bf16 v[40:43], v[104:107], v[104:107], 0
    v_mfma_f32_16x16x32_bf16 v[36:39], v[20:23], v[104:107], 0
    s_waitcnt vmcnt(5)
    v_lshlrev_b32 v48, 16, v112
    v_and_b32 v49, s36, v112
    v_lshlrev_b32 v50, 16, v113
    v_and_b32 v51, s36, v113
    v_lshlrev_b32 v52, 16, v114
    v_and_b32 v53, s36, v114
    v_lshlrev_b32 v54, 16, v115
    v_and_b32 v55, s36, v115
    v_pk_mul_f32 v[48:49], v[48:49], s[34:35]
    v_pk_mul_f32 v[50:51], v[50:51], s[34:35]
    v_pk_mul_f32 v[52:53], v[52:53], s[34:35]
    v_pk_mul_f32 v[54:55], v[54:55], s[34:35]
    v_cvt_pk_bf16_f32 v112, v48, v49
    v_cvt_pk_bf16_f32 v113, v50, v51
    v_cvt_pk_bf16_f32 v114, v52, v53
    v_cvt_pk_bf16_f32 v115, v54, v55
    v_mfma_f32_16x16x32_bf16 v[40:43], v[108:111], v[108:111], v[40:43]
    v_mfma_f32_16x16x32_bf16 v[36:39], v[24:27], v[108:111], v[36:39]
    s_waitcnt vmcnt(4)
    v_lshlrev_b32 v48, 16, v116
    v_and_b32 v49, s36, v116
    v_lshlrev_b32 v50, 16, v117
    v_and_b32 v51, s36, v117
    v_lshlrev_b32 v52, 16, v118
    v_and_b32 v53, s36, v118
    v_lshlrev_b32 v54, 16, v119
    v_and_b32 v55, s36, v119
    v_pk_mul_f32 v[48:49], v[48:49], s[34:35]
    v_pk_mul_f32 v[50:51], v[50:51], s[34:35]
    v_pk_mul_f32 v[52:53], v[52:53], s[34:35]
    v_pk_mul_f32 v[54:55], v[54:55], s[34:35]
    v_cvt_pk_bf16_f32 v116, v48, v49
    v_cvt_pk_bf16_f32 v117, v50, v51
    v_cvt_pk_bf16_f32 v118, v52, v53
    v_cvt_pk_bf16_f32 v119, v54, v55
    v_mfma_f32_16x16x32_bf16 v[40:43], v[112:115], v[112:115], v[40:43]
    v_mfma_f32_16x16x32_bf16 v[36:39], v[28:31], v[112:115], v[36:39]
    v_mfma_f32_16x16x32_bf16 v[40:43], v[116:119], v[116:119], v[40:43]
    v_mfma_f32_16x16x32_bf16 v[36:39], v[32:35], v[116:119], v[36:39]
    s_nop 6
    v_cndmask_b32 v10, 0, v40, s[48:49]
    v_cndmask_b32 v10, v10, v41, s[50:51]
    v_cndmask_b32 v10, v10, v42, s[52:53]
    v_cndmask_b32 v10, v10, v43, s[54:55]
    s_nop 1
    v_mfma_f32_16x16x4_f32 v[44:47], v3, v10, 0
    v_cvt_pk_bf16_f32 v36, 0, v36
    v_cvt_pk_bf16_f32 v37, 0, v37
    v_cvt_pk_bf16_f32 v38, 0, v38
    v_cvt_pk_bf16_f32 v39, 0, v39
    s_nop 5
    v_cvt_pk_bf16_f32 v11, 0, v44
    v_fma_f32 v36, v11, -0.5, v36
    v_fma_f32 v37, v11, -0.5, v37
    v_fma_f32 v38, v11, -0.5, v38
    v_fma_f32 v39, v11, -0.5, v39
    v_cvt_pk_bf16_f32 v36, 0, v36
    v_cvt_pk_bf16_f32 v37, 0, v37
    v_cvt_pk_bf16_f32 v38, 0, v38
    v_cvt_pk_bf16_f32 v39, 0, v39
    v_fma_f32 v36, v36, s37, -2.0
    v_fma_f32 v37, v37, s37, -2.0
    v_fma_f32 v38, v38, s37, -2.0
    v_fma_f32 v39, v39, s37, -2.0
    v_exp_f32 v36, v36
    v_exp_f32 v37, v37
    v_exp_f32 v38, v38
    v_exp_f32 v39, v39
    v_cvt_pk_bf16_f32 v36, 0, v36
    v_cvt_pk_bf16_f32 v37, 0, v37
    v_cvt_pk_bf16_f32 v38, 0, v38
    v_cvt_pk_bf16_f32 v39, 0, v39
    v_add_f32 v36, s38, v36
    v_add_f32 v37, s38, v37
    v_add_f32 v38, s38, v38
    v_add_f32 v39, s38, v39
    v_cvt_pk_bf16_f32 v56, v36, v37
    v_cvt_pk_bf16_f32 v57, v38, v39
    s_mov_b64 exec, 1
    global_atomic_add v87, v85, v86, s[16:17] offset:256 sc0 sc1
    s_mov_b64 exec, -1
    v_mfma_f32_16x16x16_bf16 v[96:99], v[56:57], v[8:9], 0
    v_mfma_f32_16x16x16_bf16 v[16:19], v[56:57], v[8:9], v[16:19]
    s_nop 6
    v_and_b32 v48, s36, v96
    v_and_b32 v49, s36, v97
    v_and_b32 v50, s36, v98
    v_and_b32 v51, s36, v99
    v_sub_f32 v48, v96, v48
    v_sub_f32 v49, v97, v49
    v_sub_f32 v50, v98, v50
    v_sub_f32 v51, v99, v51
    v_perm_b32 v60, v96, v48, v4
    v_perm_b32 v61, v96, v48, v5
    v_perm_b32 v62, v96, v48, v6
    v_perm_b32 v63, v96, v48, v7
    v_perm_b32 v64, v97, v49, v4
    v_perm_b32 v65, v97, v49, v5
    v_perm_b32 v66, v97, v49, v6
    v_perm_b32 v67, v97, v49, v7
    v_perm_b32 v68, v98, v50, v4
    v_perm_b32 v69, v98, v50, v5
    v_perm_b32 v70, v98, v50, v6
    v_perm_b32 v71, v98, v50, v7
    v_perm_b32 v72, v99, v51, v4
    v_perm_b32 v73, v99, v51, v5
    v_perm_b32 v74, v99, v51, v6
    v_perm_b32 v75, v99, v51, v7
    v_add_f32 v16, v16, v17
    v_add_f32 v18, v18, v19
    v_add_f32 v16, v16, v18
    v_mov_b32 v17, v16
    s_nop 1
    v_permlane16_swap_b32 v16, v17
    v_add_f32 v16, v16, v17
    ds_write_b32 v77, v16 offset:12288
    s_waitcnt vmcnt(4)
    v_mfma_f32_16x16x32_bf16 v[12:15], v[60:63], a[0:3], v[12:15]
    s_waitcnt vmcnt(3)
    v_mfma_f32_16x16x32_bf16 v[12:15], v[64:67], a[4:7], v[12:15]
    s_waitcnt vmcnt(2)
    v_mfma_f32_16x16x32_bf16 v[12:15], v[68:71], a[8:11], v[12:15]
    s_waitcnt vmcnt(1)
    v_mfma_f32_16x16x32_bf16 v[12:15], v[72:75], a[12:15], v[12:15]
    s_nop 7
L_final:
    ds_write_b128 v76, v[12:15] offset:8192
    s_waitcnt lgkmcnt(0)
    s_barrier
    s_cmp_lg_u32 s31, 0
    s_cbranch_scc1 L_other
    ds_read_b128 v[168:171], v78 offset:8192
    ds_read_b128 v[172:175], v78 offset:9216
    ds_read_b128 v[176:179], v78 offset:10240
    ds_read_b128 v[180:183], v78 offset:11264
    ds_read_b32 v184, v79 offset:12288
    ds_read_b32 v185, v79 offset:12544
    ds_read_b32 v186, v79 offset:12800
    ds_read_b32 v187, v79 offset:13056
    s_waitcnt lgkmcnt(0)
    v_pk_add_f32 v[168:169], v[168:169], v[176:177]
    v_pk_add_f32 v[170:171], v[170:171], v[178:179]
    v_add_f32 v184, v184, v186
    v_pk_add_f32 v[172:173], v[172:173], v[180:181]
    v_pk_add_f32 v[174:175], v[174:175], v[182:183]
    v_add_f32 v185, v185, v187
    v_pk_add_f32 v[168:169], v[168:169], v[172:173]
    v_pk_add_f32 v[170:171], v[170:171], v[174:175]
    v_add_f32 v184, v184, v185
    v_mov_b32 v172, v170
    v_permlane32_swap_b32 v168, v171
    v_permlane32_swap_b32 v169, v184
    v_permlane32_swap_b32 v170, v172
    v_add_f32 v168, v168, v171
    v_add_f32 v169, v169, v184
    v_add_f32 v170, v170, v172
    v_mov_b32 v171, s57
    buffer_store_dwordx4 v[168:171], v81, s[84:87], s88 offen offset:0 sc0 sc1
    s_waitcnt vmcnt(1)
    v_readfirstlane_b32 s18, v87
    s_cmp_lg_u32 s18, 31
    s_cbranch_scc1 L_fin
    s_branch L_cons
L_other:
    s_waitcnt vmcnt(0)
    v_readfirstlane_b32 s18, v87
    s_cmp_lg_u32 s18, 31
    s_cbranch_scc1 L_fin
    ds_read_b128 v[168:171], v78 offset:8192
    ds_read_b128 v[172:175], v78 offset:9216
    ds_read_b128 v[176:179], v78 offset:10240
    ds_read_b128 v[180:183], v78 offset:11264
    ds_read_b32 v184, v79 offset:12288
    ds_read_b32 v185, v79 offset:12544
    ds_read_b32 v186, v79 offset:12800
    ds_read_b32 v187, v79 offset:13056
    s_waitcnt lgkmcnt(0)
    v_pk_add_f32 v[168:169], v[168:169], v[176:177]
    v_pk_add_f32 v[170:171], v[170:171], v[178:179]
    v_add_f32 v184, v184, v186
    v_pk_add_f32 v[172:173], v[172:173], v[180:181]
    v_pk_add_f32 v[174:175], v[174:175], v[182:183]
    v_add_f32 v185, v185, v187
    v_pk_add_f32 v[168:169], v[168:169], v[172:173]
    v_pk_add_f32 v[170:171], v[170:171], v[174:175]
    v_add_f32 v184, v184, v185
    v_mov_b32 v172, v170
    v_permlane32_swap_b32 v168, v171
    v_permlane32_swap_b32 v169, v184
    v_permlane32_swap_b32 v170, v172
    v_add_f32 v168, v168, v171
    v_add_f32 v169, v169, v184
    v_add_f32 v170, v170, v172
    v_mov_b32 v171, s57
L_cons:
    buffer_load_dwordx4 v[140:143], v81, s[84:87], s89 offen offset:0 sc0 sc1
    buffer_load_dwordx4 v[144:147], v81, s[84:87], s90 offen offset:0 sc0 sc1
    buffer_load_dwordx4 v[148:151], v81, s[84:87], s91 offen offset:0 sc0 sc1
    buffer_load_dwordx4 v[152:155], v81, s[84:87], s92 offen offset:0 sc0 sc1
    buffer_load_dwordx4 v[156:159], v81, s[84:87], s93 offen offset:0 sc0 sc1
    buffer_load_dwordx4 v[160:163], v81, s[84:87], s94 offen offset:0 sc0 sc1
    buffer_load_dwordx4 v[164:167], v81, s[84:87], s95 offen offset:0 sc0 sc1
    s_mov_b32 s18, 0x200000
L_poll:
    s_waitcnt vmcnt(0)
    v_xor_b32 v10, s57, v143
    v_bitop3_b32 v10, v10, v147, s57 bitop3:0xf6
    v_bitop3_b32 v10, v10, v151, s57 bitop3:0xf6
    v_bitop3_b32 v10, v10, v155, s57 bitop3:0xf6
    v_bitop3_b32 v10, v10, v159, s57 bitop3:0xf6
    v_bitop3_b32 v10, v10, v163, s57 bitop3:0xf6
    v_bitop3_b32 v10, v10, v167, s57 bitop3:0xf6
    v_cmp_ne_u32 vcc, 0, v10
    s_cbranch_vccz L_ok0
    buffer_load_dwordx4 v[140:143], v81, s[84:87], s89 offen offset:0 sc0 sc1
    buffer_load_dwordx4 v[144:147], v81, s[84:87], s90 offen offset:0 sc0 sc1
    buffer_load_dwordx4 v[148:151], v81, s[84:87], s91 offen offset:0 sc0 sc1
    buffer_load_dwordx4 v[152:155], v81, s[84:87], s92 offen offset:0 sc0 sc1
    buffer_load_dwordx4 v[156:159], v81, s[84:87], s93 offen offset:0 sc0 sc1
    buffer_load_dwordx4 v[160:163], v81, s[84:87], s94 offen offset:0 sc0 sc1
    buffer_load_dwordx4 v[164:167], v81, s[84:87], s95 offen offset:0 sc0 sc1
    s_sub_u32 s18, s18, 1
    s_cbranch_scc0 L_poll
    s_branch L_fin
L_ok0:
    v_pk_add_f32 v[172:173], v[168:169], v[140:141]
    v_pk_add_f32 v[174:175], v[170:171], v[142:143]
    v_pk_add_f32 v[144:145], v[144:145], v[148:149]
    v_pk_add_f32 v[146:147], v[146:147], v[150:151]
    v_pk_add_f32 v[152:153], v[152:153], v[156:157]
    v_pk_add_f32 v[154:155], v[154:155], v[158:159]
    v_pk_add_f32 v[160:161], v[160:161], v[164:165]
    v_pk_add_f32 v[162:163], v[162:163], v[166:167]
    v_pk_add_f32 v[172:173], v[172:173], v[144:145]
    v_pk_add_f32 v[174:175], v[174:175], v[146:147]
    v_pk_add_f32 v[152:153], v[152:153], v[160:161]
    v_pk_add_f32 v[154:155], v[154:155], v[162:163]
    v_pk_add_f32 v[172:173], v[172:173], v[152:153]
    v_pk_add_f32 v[174:175], v[174:175], v[154:155]
L_sum:
    s_nop 0
    v_permlane32_swap_b32 v173, v176
    v_permlane32_swap_b32 v172, v175
    v_cvt_pk_bf16_f32 v176, 0, v176
    v_add_f32 v176, s38, v176
    v_cvt_pk_bf16_f32 v176, 0, v176
    v_rcp_f32 v176, v176
    v_cvt_pk_bf16_f32 v172, 0, v172
    v_cvt_pk_bf16_f32 v173, 0, v173
    v_cvt_pk_bf16_f32 v174, 0, v174
    v_cvt_pk_bf16_f32 v175, 0, v175
    v_mul_f32 v172, v172, v176
    v_mul_f32 v173, v173, v176
    v_mul_f32 v174, v174, v176
    v_mul_f32 v175, v175, v176
    v_cvt_pk_bf16_f32 v172, v172, v173
    v_cvt_pk_bf16_f32 v173, v174, v175
    s_mov_b32 exec_hi, 0
    global_store_dwordx2 v83, v[172:173], s[12:13]
    s_mov_b64 exec, 1
    global_store_dword v84, v171, s[16:17]
L_fin:
L_end:
    s_endpgm
L_slow:
    s_sub_u32 s59, s59, 1
    s_cbranch_scc1 L_end
    s_mov_b64 exec, 3
    global_load_dword v91, v85, s[16:17] offset:4 sc0 sc1
    s_mov_b64 exec, -1
    s_waitcnt vmcnt(0)
    v_readfirstlane_b32 s63, v91
    v_readlane_b32 s64, v91, 1
    s_xor_b32 s63, s63, s57
    s_xor_b32 s64, s64, s57
    s_or_b32 s63, s63, s64
    s_cbranch_scc1 L_slow
    s_branch L_back
L_drain15:
    v_add_f32 v16, v16, v17
    v_add_f32 v18, v18, v19
    v_add_f32 v16, v16, v18
    v_mov_b32 v17, v16
    s_nop 1
    v_permlane16_swap_b32 v16, v17
    v_add_f32 v16, v16, v17
    ds_write_b32 v77, v16 offset:12288
    s_branch L_final
L_drain16:
    v_add_f32 v16, v16, v17
    v_add_f32 v18, v18, v19
    v_add_f32 v16, v16, v18
    v_mov_b32 v17, v16
    s_nop 1
    v_permlane16_swap_b32 v16, v17
    v_add_f32 v16, v16, v17
    ds_write_b32 v77, v16 offset:12288
    s_branch L_final
.section .rodata,"a"
.p2align 6
.amdhsa_kernel standalone__linear_kernel_rfa__decode_kernel
  .amdhsa_next_free_vgpr 220
  .amdhsa_next_free_sgpr 96
  .amdhsa_accum_offset 188
  .amdhsa_group_segment_fixed_size 0
  .amdhsa_kernarg_size 56
  .amdhsa_user_sgpr_count 2
  .amdhsa_user_sgpr_kernarg_segment_ptr 1
  .amdhsa_system_sgpr_workgroup_id_x 1
  .amdhsa_float_denorm_mode_32 3
.end_amdhsa_kernel
```
